```python
import torch

def _softmax(x, axis=-1):
    return torch.softmax(x, dim=axis)
def _gelu(x):
    return torch.nn.functional.gelu(x, approximate="tanh")
def _silu(x):
    return torch.nn.functional.silu(x)
def _sigmoid(x):
    return torch.sigmoid(x)
def _layernorm(x, axis=-1, eps=1e-5):
    m = x.mean(dim=axis, keepdim=True)
    v = x.var(dim=axis, keepdim=True, unbiased=False)
    return (x - m) / torch.sqrt(v + eps)
def _scatter_add(tgt, idx, src, axis=0):
    return tgt.clone().index_add_(axis, idx, src)
def _segment_sum(src, seg, n):
    out = torch.zeros((n,) + src.shape[1:], dtype=src.dtype)
    return out.index_add_(0, seg, src)
def _pad(x, pw):
    flat = tuple(v for pair in reversed(pw) for v in pair)
    return torch.nn.functional.pad(x, flat)

kernel_name = 'standalone__gqa_softmax__near_ridge'

def setup_inputs():

    _w = (lambda a: (lambda t: t.to(torch.bfloat16) if t.is_floating_point() else t)(torch.as_tensor(a)))
    B, Hq, Hkv, Sq, Sk, D = 16, 32, 8, 320, 320, 128
    return {
        "q": _w((lambda *s: torch.randn(*s, dtype=torch.bfloat16) * 0.8)(B, Hq, Sq, D)),
        "k": _w((lambda *s: torch.randn(*s, dtype=torch.bfloat16) * 0.8)(B, Hkv, Sk, D)),
        "v": _w((lambda *s: torch.randn(*s, dtype=torch.bfloat16) * 0.05)(B, Hkv, Sk, D)),
    }

def reference(q, k, v):
    B, Hq, Sq, D = q.shape
    Hkv = k.shape[1]
    rep = Hq // Hkv
    k = (lambda x, n, axis: torch.repeat_interleave(x, n, dim=axis))(k, rep, axis=1)
    v = (lambda x, n, axis: torch.repeat_interleave(x, n, dim=axis))(v, rep, axis=1)
    scale = D ** -0.5
    scores = torch.einsum("bhqd,bhkd->bhqk", q, k) * scale
    p = _softmax(scores, axis=-1)
    return torch.einsum("bhqk,bhkd->bhqd", p, v)
```

```asm
; @launch grid=(256,1,1) block=(512,1,1) lds=163840
.amdgcn_target "amdgcn-amd-amdhsa--gfx950"
.text
.globl standalone__gqa_softmax__near_ridge_kernel
.p2align 8
.type standalone__gqa_softmax__near_ridge_kernel,@function
standalone__gqa_softmax__near_ridge_kernel:
    s_load_dwordx2 s[8:9], s[0:1], 0x8
    s_load_dwordx2 s[4:5], s[0:1], 0x0
    s_cmpk_ge_u32 s2, 0x100
    s_cbranch_scc1 L_end
    s_getpc_b64 s[38:39]
L_pc:
    s_bfe_u32 s40, s2, 0x20003
    v_lshlrev_b32 v142, 4, v0
    v_lshl_add_u32 v142, s40, 13, v142
    v_mov_b32 v143, s39
    v_add_co_u32 v142, vcc, s38, v142
    v_lshrrev_b32 v128, 6, v0
    v_and_b32 v129, 63, v0
    v_addc_co_u32 v143, vcc, 0, v143, vcc
    v_readfirstlane_b32 s20, v128
    global_load_dword v253, v[142:143], off
    s_load_dwordx2 s[12:13], s[0:1], 0x10
    s_load_dwordx2 s[16:17], s[0:1], 0x18
    v_lshrrev_b32 v130, 4, v129
    v_and_b32 v128, 15, v129
    s_and_b32 s38, s2, 7
    s_lshr_b32 s39, s2, 3
    s_lshl_b32 s38, s38, 5
    s_add_u32 s38, s38, s39
    s_lshl_b32 s39, s20, 13
    s_mul_i32 s21, s38, 163840
    s_add_u32 s28, s39, 131072
    s_add_u32 s21, s21, s39
    s_lshr_b32 s38, s38, 1
    s_mul_i32 s41, s38, 81920
    s_mov_b32 s11, 0x20000
    s_mov_b32 s7, 0x20000
    s_mov_b32 s10, 10485760
    s_mov_b32 s6, 41943040
    s_add_u32 s22, s21, 4096
    s_cmp_ge_u32 s20, 4
    s_cbranch_scc1 L_b1
    v_xor_b32 v133, v128, v130
    v_lshlrev_b32 v133, 4, v133
    v_lshl_add_u32 v208, v130, 8, v133
    v_xor_b32 v209, 64, v208
    v_xor_b32 v210, 128, v208
    v_xor_b32 v211, 192, v208
    s_mov_b32 m0, s28
    s_waitcnt lgkmcnt(0)
    buffer_load_dwordx4 v208, s[4:7], s21 offen offset:0 nt lds
    buffer_load_dwordx4 v209, s[4:7], s21 offen offset:1024 nt lds
    buffer_load_dwordx4 v210, s[4:7], s21 offen offset:2048 nt lds
    buffer_load_dwordx4 v211, s[4:7], s21 offen offset:3072 nt lds
    s_add_u32 m0, s28, 4096
    s_nop 0
    buffer_load_dwordx4 v208, s[4:7], s22 offen offset:0 nt lds
    buffer_load_dwordx4 v209, s[4:7], s22 offen offset:1024 nt lds
    buffer_load_dwordx4 v210, s[4:7], s22 offen offset:2048 nt lds
    buffer_load_dwordx4 v211, s[4:7], s22 offen offset:3072 nt lds
    s_branch L_a2
L_b1:
    s_setprio 3
    s_and_b32 s37, s20, 3
    v_lshrrev_b32 v131, 2, v128
    v_and_b32 v132, 3, v129
    v_lshlrev_b32 v134, 4, v132
    v_lshl_add_u32 v134, v130, 6, v134
    v_lshl_add_u32 v136, v131, 8, v134
    s_lshl_b32 s38, s37, 11
    s_add_u32 s32, s41, s38
    s_waitcnt lgkmcnt(0)
    buffer_load_dwordx4 v[0:3], v136, s[8:11], s32 offen offset:0 nt
    buffer_load_dwordx4 v[4:7], v136, s[8:11], s32 offen offset:1024 nt
    s_add_u32 s31, s32, 8192
    buffer_load_dwordx4 v[8:11], v136, s[8:11], s31 offen offset:0 nt
    buffer_load_dwordx4 v[12:15], v136, s[8:11], s31 offen offset:1024 nt
    s_setprio 0
    v_lshl_add_u32 v137, v131, 10, v134
    s_lshl_b32 s38, s37, 12
    s_add_u32 s36, s41, s38
    s_mov_b32 s14, 10485760
    s_mov_b32 s15, 0x20000
    buffer_load_dwordx4 v[228:231], v137, s[12:15], s36 offen offset:0 nt
    buffer_load_dwordx4 v[232:235], v137, s[12:15], s36 offen offset:256 nt
    buffer_load_dwordx4 v[236:239], v137, s[12:15], s36 offen offset:512 nt
    buffer_load_dwordx4 v[240:243], v137, s[12:15], s36 offen offset:768 nt
    s_add_u32 s31, s32, 16384
    buffer_load_dwordx4 v[16:19], v136, s[8:11], s31 offen offset:0 nt
    buffer_load_dwordx4 v[20:23], v136, s[8:11], s31 offen offset:1024 nt
    s_mov_b32 s27, 0x3e0293ee
    s_mov_b32 s34, 0x05040100
    s_mov_b32 s35, 0x07060302
    s_and_b32 s38, s37, 1
    s_mul_i32 s40, s38, 3
    v_xor_b32 v135, s40, v132
    v_lshl_add_u32 v135, v131, 2, v135
    v_lshlrev_b32 v135, 4, v135
    v_lshl_add_u32 v135, v130, 10, v135
    s_lshl_b32 s39, s38, 9
    s_lshr_b32 s40, s37, 1
    s_lshl_b32 s40, s40, 12
    s_add_u32 s39, s39, s40
    v_add_u32 v138, s39, v135
    v_xor_b32 v139, 32, v138
    v_add_u32 v139, 0x100, v139
    v_and_b32 v135, 1, v131
    v_lshl_add_u32 v135, v135, 2, v132
    v_lshl_add_u32 v135, v131, 4, v135
    v_lshlrev_b32 v135, 4, v135
    v_lshl_add_u32 v135, v130, 11, v135
    s_lshl_b32 s40, s40, 1
    s_lshl_b32 s38, s38, 3
    s_add_u32 s38, s38, s40
    s_add_u32 s38, s38, 81920
    v_add_u32 v140, s38, v135
    v_xor_b32 v141, 64, v140
    s_mov_b32 s18, 41943040
    s_mov_b32 s19, 0x20000
    s_mov_b32 s29, 0x47800000
    s_add_u32 s23, s21, 0x10000
    s_add_u32 s24, s21, 0x11000
    s_add_u32 s25, s21, 0x20000
    s_add_u32 s26, s21, 0x21000
    v_lshrrev_b32 v249, 1, v131
    v_xor_b32 v135, v131, v249
    v_and_b32 v135, 1, v135
    v_lshl_add_u32 v135, v135, 1, v249
    v_xor_b32 v135, v135, v130
    v_lshl_add_u32 v135, v128, 2, v135
    v_lshlrev_b32 v248, 4, v135
    v_add_u32 v249, 0x10000, v248
    v_lshlrev_b32 v135, 8, v128
    v_lshl_add_u32 v252, v130, 4, v135
    v_and_b32 v135, 1, v130
    v_xor_b32 v135, v135, v132
    v_lshl_add_u32 v135, v135, 2, v131
    v_lshl_add_u32 v135, v130, 4, v135
    v_lshlrev_b32 v135, 4, v135
    v_add_u32 v250, 81920, v135
    v_add_u32 v251, 147456, v135
    v_mov_b32 v224, 0x3f803f80
    v_mov_b32 v225, 0x3f803f80
    v_mov_b32 v226, 0x3f803f80
    v_mov_b32 v227, 0x3f803f80
    s_waitcnt vmcnt(9)
    s_add_u32 s31, s32, 24576
    buffer_load_dwordx4 v[24:27], v136, s[8:11], s31 offen offset:0 nt
    v_lshlrev_b32 v192, 16, v0
    v_and_b32 v193, 0xffff0000, v0
    v_lshlrev_b32 v194, 16, v1
    v_and_b32 v195, 0xffff0000, v1
    v_lshlrev_b32 v196, 16, v2
    v_and_b32 v197, 0xffff0000, v2
    v_lshlrev_b32 v198, 16, v3
    v_and_b32 v199, 0xffff0000, v3
    v_mul_f32 v192, s27, v192
    v_mul_f32 v193, s27, v193
    v_mul_f32 v194, s27, v194
    v_mul_f32 v195, s27, v195
    v_mul_f32 v196, s27, v196
    v_mul_f32 v197, s27, v197
    v_mul_f32 v198, s27, v198
    v_mul_f32 v199, s27, v199
    v_cvt_pk_bf16_f32 v0, v192, v193
    v_cvt_pk_bf16_f32 v1, v194, v195
    v_cvt_pk_bf16_f32 v2, v196, v197
    v_cvt_pk_bf16_f32 v3, v198, v199
    ds_write_b128 v138, v[0:3] offset:0
    s_waitcnt vmcnt(9)
    buffer_load_dwordx4 v[28:31], v136, s[8:11], s31 offen offset:1024 nt
    v_lshlrev_b32 v200, 16, v4
    v_and_b32 v201, 0xffff0000, v4
    v_lshlrev_b32 v202, 16, v5
    v_and_b32 v203, 0xffff0000, v5
    v_lshlrev_b32 v204, 16, v6
    v_and_b32 v205, 0xffff0000, v6
    v_lshlrev_b32 v206, 16, v7
    v_and_b32 v207, 0xffff0000, v7
    v_mul_f32 v200, s27, v200
    v_mul_f32 v201, s27, v201
    v_mul_f32 v202, s27, v202
    v_mul_f32 v203, s27, v203
    v_mul_f32 v204, s27, v204
    v_mul_f32 v205, s27, v205
    v_mul_f32 v206, s27, v206
    v_mul_f32 v207, s27, v207
    v_cvt_pk_bf16_f32 v4, v200, v201
    v_cvt_pk_bf16_f32 v5, v202, v203
    v_cvt_pk_bf16_f32 v6, v204, v205
    v_cvt_pk_bf16_f32 v7, v206, v207
    ds_write_b128 v139, v[4:7] offset:0
    s_waitcnt vmcnt(9)
    s_add_u32 s33, s36, 16384
    buffer_load_dwordx4 v[144:147], v137, s[12:15], s33 offen offset:0 nt
    v_lshlrev_b32 v192, 16, v8
    v_and_b32 v193, 0xffff0000, v8
    v_lshlrev_b32 v194, 16, v9
    v_and_b32 v195, 0xffff0000, v9
    v_lshlrev_b32 v196, 16, v10
    v_and_b32 v197, 0xffff0000, v10
    v_lshlrev_b32 v198, 16, v11
    v_and_b32 v199, 0xffff0000, v11
    v_mul_f32 v192, s27, v192
    v_mul_f32 v193, s27, v193
    v_mul_f32 v194, s27, v194
    v_mul_f32 v195, s27, v195
    v_mul_f32 v196, s27, v196
    v_mul_f32 v197, s27, v197
    v_mul_f32 v198, s27, v198
    v_mul_f32 v199, s27, v199
    v_cvt_pk_bf16_f32 v8, v192, v193
    v_cvt_pk_bf16_f32 v9, v194, v195
    v_cvt_pk_bf16_f32 v10, v196, v197
    v_cvt_pk_bf16_f32 v11, v198, v199
    ds_write_b128 v138, v[8:11] offset:8192
    s_waitcnt vmcnt(9)
    buffer_load_dwordx4 v[148:151], v137, s[12:15], s33 offen offset:256 nt
    v_lshlrev_b32 v200, 16, v12
    v_and_b32 v201, 0xffff0000, v12
    v_lshlrev_b32 v202, 16, v13
    v_and_b32 v203, 0xffff0000, v13
    v_lshlrev_b32 v204, 16, v14
    v_and_b32 v205, 0xffff0000, v14
    v_lshlrev_b32 v206, 16, v15
    v_and_b32 v207, 0xffff0000, v15
    v_mul_f32 v200, s27, v200
    v_mul_f32 v201, s27, v201
    v_mul_f32 v202, s27, v202
    v_mul_f32 v203, s27, v203
    v_mul_f32 v204, s27, v204
    v_mul_f32 v205, s27, v205
    v_mul_f32 v206, s27, v206
    v_mul_f32 v207, s27, v207
    v_cvt_pk_bf16_f32 v12, v200, v201
    v_cvt_pk_bf16_f32 v13, v202, v203
    v_cvt_pk_bf16_f32 v14, v204, v205
    v_cvt_pk_bf16_f32 v15, v206, v207
    ds_write_b128 v139, v[12:15] offset:8192
    s_waitcnt lgkmcnt(0)
    s_barrier
    s_setprio 3
    s_waitcnt vmcnt(6)
    buffer_load_dwordx4 v[152:155], v137, s[12:15], s33 offen offset:512 nt
    buffer_load_dwordx4 v[156:159], v137, s[12:15], s33 offen offset:768 nt
    s_add_u32 s31, s32, 32768
    buffer_load_dwordx4 v[32:35], v136, s[8:11], s31 offen offset:0 nt
    buffer_load_dwordx4 v[36:39], v136, s[8:11], s31 offen offset:1024 nt
    v_perm_b32 v128, v232, v228, s34
    v_perm_b32 v129, v240, v236, s34
    ds_write_b64 v140, v[128:129] offset:0
    v_perm_b32 v130, v232, v228, s35
    v_perm_b32 v131, v240, v236, s35
    ds_write_b64 v141, v[130:131] offset:0
    v_perm_b32 v132, v233, v229, s34
    v_perm_b32 v133, v241, v237, s34
    ds_write_b64 v140, v[132:133] offset:128
    v_perm_b32 v134, v233, v229, s35
    v_perm_b32 v135, v241, v237, s35
    ds_write_b64 v141, v[134:135] offset:128
    v_perm_b32 v128, v234, v230, s34
    v_perm_b32 v129, v242, v238, s34
    ds_write_b64 v140, v[128:129] offset:1024
    v_perm_b32 v130, v234, v230, s35
    v_perm_b32 v131, v242, v238, s35
    ds_write_b64 v141, v[130:131] offset:1024
    v_perm_b32 v132, v235, v231, s34
    v_perm_b32 v133, v243, v239, s34
    ds_write_b64 v140, v[132:133] offset:1152
    v_perm_b32 v134, v235, v231, s35
    v_perm_b32 v135, v243, v239, s35
    ds_write_b64 v141, v[134:135] offset:1152
    s_waitcnt vmcnt(9)
    s_add_u32 s31, s32, 40960
    buffer_load_dwordx4 v[40:43], v136, s[8:11], s31 offen offset:0 nt
    v_lshlrev_b32 v192, 16, v16
    v_and_b32 v193, 0xffff0000, v16
    v_lshlrev_b32 v194, 16, v17
    v_and_b32 v195, 0xffff0000, v17
    v_lshlrev_b32 v196, 16, v18
    v_and_b32 v197, 0xffff0000, v18
    v_lshlrev_b32 v198, 16, v19
    v_and_b32 v199, 0xffff0000, v19
    v_mul_f32 v192, s27, v192
    v_mul_f32 v193, s27, v193
    v_mul_f32 v194, s27, v194
    v_mul_f32 v195, s27, v195
    v_mul_f32 v196, s27, v196
    v_mul_f32 v197, s27, v197
    v_mul_f32 v198, s27, v198
    v_mul_f32 v199, s27, v199
    v_cvt_pk_bf16_f32 v16, v192, v193
    v_cvt_pk_bf16_f32 v17, v194, v195
    v_cvt_pk_bf16_f32 v18, v196, v197
    v_cvt_pk_bf16_f32 v19, v198, v199
    ds_write_b128 v138, v[16:19] offset:16384
    s_waitcnt vmcnt(9)
    buffer_load_dwordx4 v[44:47], v136, s[8:11], s31 offen offset:1024 nt
    v_lshlrev_b32 v200, 16, v20
    v_and_b32 v201, 0xffff0000, v20
    v_lshlrev_b32 v202, 16, v21
    v_and_b32 v203, 0xffff0000, v21
    v_lshlrev_b32 v204, 16, v22
    v_and_b32 v205, 0xffff0000, v22
    v_lshlrev_b32 v206, 16, v23
    v_and_b32 v207, 0xffff0000, v23
    v_mul_f32 v200, s27, v200
    v_mul_f32 v201, s27, v201
    v_mul_f32 v202, s27, v202
    v_mul_f32 v203, s27, v203
    v_mul_f32 v204, s27, v204
    v_mul_f32 v205, s27, v205
    v_mul_f32 v206, s27, v206
    v_mul_f32 v207, s27, v207
    v_cvt_pk_bf16_f32 v20, v200, v201
    v_cvt_pk_bf16_f32 v21, v202, v203
    v_cvt_pk_bf16_f32 v22, v204, v205
    v_cvt_pk_bf16_f32 v23, v206, v207
    ds_write_b128 v139, v[20:23] offset:16384
    s_waitcnt lgkmcnt(0)
    s_barrier
    s_waitcnt vmcnt(9)
    s_add_u32 s33, s36, 32768
    buffer_load_dwordx4 v[96:99], v137, s[12:15], s33 offen offset:0 nt
    v_lshlrev_b32 v192, 16, v24
    v_and_b32 v193, 0xffff0000, v24
    v_lshlrev_b32 v194, 16, v25
    v_and_b32 v195, 0xffff0000, v25
    v_lshlrev_b32 v196, 16, v26
    v_and_b32 v197, 0xffff0000, v26
    v_lshlrev_b32 v198, 16, v27
    v_and_b32 v199, 0xffff0000, v27
    v_mul_f32 v192, s27, v192
    v_mul_f32 v193, s27, v193
    v_mul_f32 v194, s27, v194
    v_mul_f32 v195, s27, v195
    v_mul_f32 v196, s27, v196
    v_mul_f32 v197, s27, v197
    v_mul_f32 v198, s27, v198
    v_mul_f32 v199, s27, v199
    v_cvt_pk_bf16_f32 v24, v192, v193
    v_cvt_pk_bf16_f32 v25, v194, v195
    v_cvt_pk_bf16_f32 v26, v196, v197
    v_cvt_pk_bf16_f32 v27, v198, v199
    ds_write_b128 v138, v[24:27] offset:24576
    s_waitcnt vmcnt(9)
    buffer_load_dwordx4 v[100:103], v137, s[12:15], s33 offen offset:256 nt
    v_lshlrev_b32 v200, 16, v28
    v_and_b32 v201, 0xffff0000, v28
    v_lshlrev_b32 v202, 16, v29
    v_and_b32 v203, 0xffff0000, v29
    v_lshlrev_b32 v204, 16, v30
    v_and_b32 v205, 0xffff0000, v30
    v_lshlrev_b32 v206, 16, v31
    v_and_b32 v207, 0xffff0000, v31
    v_mul_f32 v200, s27, v200
    v_mul_f32 v201, s27, v201
    v_mul_f32 v202, s27, v202
    v_mul_f32 v203, s27, v203
    v_mul_f32 v204, s27, v204
    v_mul_f32 v205, s27, v205
    v_mul_f32 v206, s27, v206
    v_mul_f32 v207, s27, v207
    v_cvt_pk_bf16_f32 v28, v200, v201
    v_cvt_pk_bf16_f32 v29, v202, v203
    v_cvt_pk_bf16_f32 v30, v204, v205
    v_cvt_pk_bf16_f32 v31, v206, v207
    ds_write_b128 v139, v[28:31] offset:24576
    s_waitcnt vmcnt(6)
    buffer_load_dwordx4 v[104:107], v137, s[12:15], s33 offen offset:512 nt
    buffer_load_dwordx4 v[108:111], v137, s[12:15], s33 offen offset:768 nt
    s_add_u32 s31, s32, 49152
    buffer_load_dwordx4 v[48:51], v136, s[8:11], s31 offen offset:0 nt
    buffer_load_dwordx4 v[52:55], v136, s[8:11], s31 offen offset:1024 nt
    v_perm_b32 v128, v148, v144, s34
    v_perm_b32 v129, v156, v152, s34
    ds_write_b64 v140, v[128:129] offset:16384
    v_perm_b32 v130, v148, v144, s35
    v_perm_b32 v131, v156, v152, s35
    ds_write_b64 v141, v[130:131] offset:16384
    v_perm_b32 v132, v149, v145, s34
    v_perm_b32 v133, v157, v153, s34
    ds_write_b64 v140, v[132:133] offset:16512
    v_perm_b32 v134, v149, v145, s35
    v_perm_b32 v135, v157, v153, s35
    ds_write_b64 v141, v[134:135] offset:16512
    v_perm_b32 v128, v150, v146, s34
    v_perm_b32 v129, v158, v154, s34
    ds_write_b64 v140, v[128:129] offset:17408
    v_perm_b32 v130, v150, v146, s35
    v_perm_b32 v131, v158, v154, s35
    ds_write_b64 v141, v[130:131] offset:17408
    v_perm_b32 v132, v151, v147, s34
    v_perm_b32 v133, v159, v155, s34
    ds_write_b64 v140, v[132:133] offset:17536
    v_perm_b32 v134, v151, v147, s35
    v_perm_b32 v135, v159, v155, s35
    ds_write_b64 v141, v[134:135] offset:17536
    s_waitcnt vmcnt(9)
    s_add_u32 s31, s32, 57344
    buffer_load_dwordx4 v[56:59], v136, s[8:11], s31 offen offset:0 nt
    v_lshlrev_b32 v192, 16, v32
    v_and_b32 v193, 0xffff0000, v32
    v_lshlrev_b32 v194, 16, v33
    v_and_b32 v195, 0xffff0000, v33
    v_lshlrev_b32 v196, 16, v34
    v_and_b32 v197, 0xffff0000, v34
    v_lshlrev_b32 v198, 16, v35
    v_and_b32 v199, 0xffff0000, v35
    v_mul_f32 v192, s27, v192
    v_mul_f32 v193, s27, v193
    v_mul_f32 v194, s27, v194
    v_mul_f32 v195, s27, v195
    v_mul_f32 v196, s27, v196
    v_mul_f32 v197, s27, v197
    v_mul_f32 v198, s27, v198
    v_mul_f32 v199, s27, v199
    v_cvt_pk_bf16_f32 v32, v192, v193
    v_cvt_pk_bf16_f32 v33, v194, v195
    v_cvt_pk_bf16_f32 v34, v196, v197
    v_cvt_pk_bf16_f32 v35, v198, v199
    ds_write_b128 v138, v[32:35] offset:32768
    s_waitcnt vmcnt(9)
    buffer_load_dwordx4 v[60:63], v136, s[8:11], s31 offen offset:1024 nt
    v_lshlrev_b32 v200, 16, v36
    v_and_b32 v201, 0xffff0000, v36
    v_lshlrev_b32 v202, 16, v37
    v_and_b32 v203, 0xffff0000, v37
    v_lshlrev_b32 v204, 16, v38
    v_and_b32 v205, 0xffff0000, v38
    v_lshlrev_b32 v206, 16, v39
    v_and_b32 v207, 0xffff0000, v39
    v_mul_f32 v200, s27, v200
    v_mul_f32 v201, s27, v201
    v_mul_f32 v202, s27, v202
    v_mul_f32 v203, s27, v203
    v_mul_f32 v204, s27, v204
    v_mul_f32 v205, s27, v205
    v_mul_f32 v206, s27, v206
    v_mul_f32 v207, s27, v207
    v_cvt_pk_bf16_f32 v36, v200, v201
    v_cvt_pk_bf16_f32 v37, v202, v203
    v_cvt_pk_bf16_f32 v38, v204, v205
    v_cvt_pk_bf16_f32 v39, v206, v207
    ds_write_b128 v139, v[36:39] offset:32768
    s_waitcnt lgkmcnt(0)
    s_barrier
    s_waitcnt vmcnt(9)
    s_add_u32 s33, s36, 49152
    buffer_load_dwordx4 v[112:115], v137, s[12:15], s33 offen offset:0 nt
    v_lshlrev_b32 v192, 16, v40
    v_and_b32 v193, 0xffff0000, v40
    v_lshlrev_b32 v194, 16, v41
    v_and_b32 v195, 0xffff0000, v41
    v_lshlrev_b32 v196, 16, v42
    v_and_b32 v197, 0xffff0000, v42
    v_lshlrev_b32 v198, 16, v43
    v_and_b32 v199, 0xffff0000, v43
    v_mul_f32 v192, s27, v192
    v_mul_f32 v193, s27, v193
    v_mul_f32 v194, s27, v194
    v_mul_f32 v195, s27, v195
    v_mul_f32 v196, s27, v196
    v_mul_f32 v197, s27, v197
    v_mul_f32 v198, s27, v198
    v_mul_f32 v199, s27, v199
    v_cvt_pk_bf16_f32 v40, v192, v193
    v_cvt_pk_bf16_f32 v41, v194, v195
    v_cvt_pk_bf16_f32 v42, v196, v197
    v_cvt_pk_bf16_f32 v43, v198, v199
    ds_write_b128 v138, v[40:43] offset:40960
    s_waitcnt vmcnt(9)
    buffer_load_dwordx4 v[116:119], v137, s[12:15], s33 offen offset:256 nt
    v_lshlrev_b32 v200, 16, v44
    v_and_b32 v201, 0xffff0000, v44
    v_lshlrev_b32 v202, 16, v45
    v_and_b32 v203, 0xffff0000, v45
    v_lshlrev_b32 v204, 16, v46
    v_and_b32 v205, 0xffff0000, v46
    v_lshlrev_b32 v206, 16, v47
    v_and_b32 v207, 0xffff0000, v47
    v_mul_f32 v200, s27, v200
    v_mul_f32 v201, s27, v201
    v_mul_f32 v202, s27, v202
    v_mul_f32 v203, s27, v203
    v_mul_f32 v204, s27, v204
    v_mul_f32 v205, s27, v205
    v_mul_f32 v206, s27, v206
    v_mul_f32 v207, s27, v207
    v_cvt_pk_bf16_f32 v44, v200, v201
    v_cvt_pk_bf16_f32 v45, v202, v203
    v_cvt_pk_bf16_f32 v46, v204, v205
    v_cvt_pk_bf16_f32 v47, v206, v207
    ds_write_b128 v139, v[44:47] offset:40960
    s_waitcnt vmcnt(6)
    buffer_load_dwordx4 v[120:123], v137, s[12:15], s33 offen offset:512 nt
    buffer_load_dwordx4 v[124:127], v137, s[12:15], s33 offen offset:768 nt
    s_add_u32 s31, s32, 65536
    buffer_load_dwordx4 v[160:163], v136, s[8:11], s31 offen offset:0 nt
    buffer_load_dwordx4 v[164:167], v136, s[8:11], s31 offen offset:1024 nt
    v_perm_b32 v128, v100, v96, s34
    v_perm_b32 v129, v108, v104, s34
    ds_write_b64 v140, v[128:129] offset:32768
    v_perm_b32 v130, v100, v96, s35
    v_perm_b32 v131, v108, v104, s35
    ds_write_b64 v141, v[130:131] offset:32768
    v_perm_b32 v132, v101, v97, s34
    v_perm_b32 v133, v109, v105, s34
    ds_write_b64 v140, v[132:133] offset:32896
    v_perm_b32 v134, v101, v97, s35
    v_perm_b32 v135, v109, v105, s35
    ds_write_b64 v141, v[134:135] offset:32896
    s_waitcnt lgkmcnt(0)
    s_barrier
    v_perm_b32 v128, v102, v98, s34
    v_perm_b32 v129, v110, v106, s34
    ds_write_b64 v140, v[128:129] offset:33792
    v_perm_b32 v130, v102, v98, s35
    v_perm_b32 v131, v110, v106, s35
    ds_write_b64 v141, v[130:131] offset:33792
    v_perm_b32 v132, v103, v99, s34
    v_perm_b32 v133, v111, v107, s34
    ds_write_b64 v140, v[132:133] offset:33920
    v_perm_b32 v134, v103, v99, s35
    v_perm_b32 v135, v111, v107, s35
    ds_write_b64 v141, v[134:135] offset:33920
    s_waitcnt vmcnt(9)
    s_add_u32 s31, s32, 73728
    buffer_load_dwordx4 v[168:171], v136, s[8:11], s31 offen offset:0 nt
    v_lshlrev_b32 v192, 16, v48
    v_and_b32 v193, 0xffff0000, v48
    v_lshlrev_b32 v194, 16, v49
    v_and_b32 v195, 0xffff0000, v49
    v_lshlrev_b32 v196, 16, v50
    v_and_b32 v197, 0xffff0000, v50
    v_lshlrev_b32 v198, 16, v51
    v_and_b32 v199, 0xffff0000, v51
    v_mul_f32 v192, s27, v192
    v_mul_f32 v193, s27, v193
    v_mul_f32 v194, s27, v194
    v_mul_f32 v195, s27, v195
    v_mul_f32 v196, s27, v196
    v_mul_f32 v197, s27, v197
    v_mul_f32 v198, s27, v198
    v_mul_f32 v199, s27, v199
    v_cvt_pk_bf16_f32 v48, v192, v193
    v_cvt_pk_bf16_f32 v49, v194, v195
    v_cvt_pk_bf16_f32 v50, v196, v197
    v_cvt_pk_bf16_f32 v51, v198, v199
    ds_write_b128 v138, v[48:51] offset:49152
    s_waitcnt vmcnt(9)
    buffer_load_dwordx4 v[172:175], v136, s[8:11], s31 offen offset:1024 nt
    v_lshlrev_b32 v200, 16, v52
    v_and_b32 v201, 0xffff0000, v52
    v_lshlrev_b32 v202, 16, v53
    v_and_b32 v203, 0xffff0000, v53
    v_lshlrev_b32 v204, 16, v54
    v_and_b32 v205, 0xffff0000, v54
    v_lshlrev_b32 v206, 16, v55
    v_and_b32 v207, 0xffff0000, v55
    v_mul_f32 v200, s27, v200
    v_mul_f32 v201, s27, v201
    v_mul_f32 v202, s27, v202
    v_mul_f32 v203, s27, v203
    v_mul_f32 v204, s27, v204
    v_mul_f32 v205, s27, v205
    v_mul_f32 v206, s27, v206
    v_mul_f32 v207, s27, v207
    v_cvt_pk_bf16_f32 v52, v200, v201
    v_cvt_pk_bf16_f32 v53, v202, v203
    v_cvt_pk_bf16_f32 v54, v204, v205
    v_cvt_pk_bf16_f32 v55, v206, v207
    ds_write_b128 v139, v[52:55] offset:49152
    s_waitcnt lgkmcnt(0)
    s_barrier
    s_waitcnt vmcnt(9)
    s_add_u32 s33, s36, 65536
    buffer_load_dwordx4 v[176:179], v137, s[12:15], s33 offen offset:0 nt
    v_lshlrev_b32 v192, 16, v56
    v_and_b32 v193, 0xffff0000, v56
    v_lshlrev_b32 v194, 16, v57
    v_and_b32 v195, 0xffff0000, v57
    v_lshlrev_b32 v196, 16, v58
    v_and_b32 v197, 0xffff0000, v58
    v_lshlrev_b32 v198, 16, v59
    v_and_b32 v199, 0xffff0000, v59
    v_mul_f32 v192, s27, v192
    v_mul_f32 v193, s27, v193
    v_mul_f32 v194, s27, v194
    v_mul_f32 v195, s27, v195
    v_mul_f32 v196, s27, v196
    v_mul_f32 v197, s27, v197
    v_mul_f32 v198, s27, v198
    v_mul_f32 v199, s27, v199
    v_cvt_pk_bf16_f32 v56, v192, v193
    v_cvt_pk_bf16_f32 v57, v194, v195
    v_cvt_pk_bf16_f32 v58, v196, v197
    v_cvt_pk_bf16_f32 v59, v198, v199
    ds_write_b128 v138, v[56:59] offset:57344
    s_waitcnt vmcnt(9)
    buffer_load_dwordx4 v[180:183], v137, s[12:15], s33 offen offset:256 nt
    v_lshlrev_b32 v200, 16, v60
    v_and_b32 v201, 0xffff0000, v60
    v_lshlrev_b32 v202, 16, v61
    v_and_b32 v203, 0xffff0000, v61
    v_lshlrev_b32 v204, 16, v62
    v_and_b32 v205, 0xffff0000, v62
    v_lshlrev_b32 v206, 16, v63
    v_and_b32 v207, 0xffff0000, v63
    v_mul_f32 v200, s27, v200
    v_mul_f32 v201, s27, v201
    v_mul_f32 v202, s27, v202
    v_mul_f32 v203, s27, v203
    v_mul_f32 v204, s27, v204
    v_mul_f32 v205, s27, v205
    v_mul_f32 v206, s27, v206
    v_mul_f32 v207, s27, v207
    v_cvt_pk_bf16_f32 v60, v200, v201
    v_cvt_pk_bf16_f32 v61, v202, v203
    v_cvt_pk_bf16_f32 v62, v204, v205
    v_cvt_pk_bf16_f32 v63, v206, v207
    ds_write_b128 v139, v[60:63] offset:57344
    s_waitcnt vmcnt(6)
    buffer_load_dwordx4 v[184:187], v137, s[12:15], s33 offen offset:512 nt
    buffer_load_dwordx4 v[188:191], v137, s[12:15], s33 offen offset:768 nt
    buffer_load_dwordx4 v[64:67], v252, s[4:7], s21 offen offset:0 nt
    buffer_load_dwordx4 v[68:71], v252, s[4:7], s21 offen offset:64 nt
    v_perm_b32 v128, v116, v112, s34
    v_perm_b32 v129, v124, v120, s34
    ds_write_b64 v140, v[128:129] offset:49152
    v_perm_b32 v130, v116, v112, s35
    v_perm_b32 v131, v124, v120, s35
    ds_write_b64 v141, v[130:131] offset:49152
    v_perm_b32 v132, v117, v113, s34
    v_perm_b32 v133, v125, v121, s34
    ds_write_b64 v140, v[132:133] offset:49280
    v_perm_b32 v134, v117, v113, s35
    v_perm_b32 v135, v125, v121, s35
    ds_write_b64 v141, v[134:135] offset:49280
    s_waitcnt lgkmcnt(0)
    s_barrier
    v_perm_b32 v128, v118, v114, s34
    v_perm_b32 v129, v126, v122, s34
    ds_write_b64 v140, v[128:129] offset:50176
    v_perm_b32 v130, v118, v114, s35
    v_perm_b32 v131, v126, v122, s35
    ds_write_b64 v141, v[130:131] offset:50176
    v_perm_b32 v132, v119, v115, s34
    v_perm_b32 v133, v127, v123, s34
    ds_write_b64 v140, v[132:133] offset:50304
    v_perm_b32 v134, v119, v115, s35
    v_perm_b32 v135, v127, v123, s35
    ds_write_b64 v141, v[134:135] offset:50304
    s_waitcnt vmcnt(9)
    buffer_load_dwordx4 v[72:75], v252, s[4:7], s21 offen offset:128 nt
    v_add_u32 v138, 0x10000, v138
    v_add_u32 v139, 0x10000, v139
    v_lshlrev_b32 v192, 16, v160
    v_and_b32 v193, 0xffff0000, v160
    v_lshlrev_b32 v194, 16, v161
    v_and_b32 v195, 0xffff0000, v161
    v_lshlrev_b32 v196, 16, v162
    v_and_b32 v197, 0xffff0000, v162
    v_lshlrev_b32 v198, 16, v163
    v_and_b32 v199, 0xffff0000, v163
    v_mul_f32 v192, s27, v192
    v_mul_f32 v193, s27, v193
    v_mul_f32 v194, s27, v194
    v_mul_f32 v195, s27, v195
    v_mul_f32 v196, s27, v196
    v_mul_f32 v197, s27, v197
    v_mul_f32 v198, s27, v198
    v_mul_f32 v199, s27, v199
    v_cvt_pk_bf16_f32 v160, v192, v193
    v_cvt_pk_bf16_f32 v161, v194, v195
    v_cvt_pk_bf16_f32 v162, v196, v197
    v_cvt_pk_bf16_f32 v163, v198, v199
    ds_write_b128 v138, v[160:163] offset:0
    s_waitcnt vmcnt(9)
    buffer_load_dwordx4 v[76:79], v252, s[4:7], s21 offen offset:192 nt
    v_lshlrev_b32 v200, 16, v164
    v_and_b32 v201, 0xffff0000, v164
    v_lshlrev_b32 v202, 16, v165
    v_and_b32 v203, 0xffff0000, v165
    v_lshlrev_b32 v204, 16, v166
    v_and_b32 v205, 0xffff0000, v166
    v_lshlrev_b32 v206, 16, v167
    v_and_b32 v207, 0xffff0000, v167
    v_mul_f32 v200, s27, v200
    v_mul_f32 v201, s27, v201
    v_mul_f32 v202, s27, v202
    v_mul_f32 v203, s27, v203
    v_mul_f32 v204, s27, v204
    v_mul_f32 v205, s27, v205
    v_mul_f32 v206, s27, v206
    v_mul_f32 v207, s27, v207
    v_cvt_pk_bf16_f32 v164, v200, v201
    v_cvt_pk_bf16_f32 v165, v202, v203
    v_cvt_pk_bf16_f32 v166, v204, v205
    v_cvt_pk_bf16_f32 v167, v206, v207
    ds_write_b128 v139, v[164:167] offset:0
    s_waitcnt lgkmcnt(0)
    s_barrier
    s_waitcnt vmcnt(9)
    buffer_load_dwordx4 v[80:83], v252, s[4:7], s22 offen offset:0 nt
    v_lshlrev_b32 v192, 16, v168
    v_and_b32 v193, 0xffff0000, v168
    v_lshlrev_b32 v194, 16, v169
    v_and_b32 v195, 0xffff0000, v169
    v_lshlrev_b32 v196, 16, v170
    v_and_b32 v197, 0xffff0000, v170
    v_lshlrev_b32 v198, 16, v171
    v_and_b32 v199, 0xffff0000, v171
    v_mul_f32 v192, s27, v192
    v_mul_f32 v193, s27, v193
    v_mul_f32 v194, s27, v194
    v_mul_f32 v195, s27, v195
    v_mul_f32 v196, s27, v196
    v_mul_f32 v197, s27, v197
    v_mul_f32 v198, s27, v198
    v_mul_f32 v199, s27, v199
    v_cvt_pk_bf16_f32 v168, v192, v193
    v_cvt_pk_bf16_f32 v169, v194, v195
    v_cvt_pk_bf16_f32 v170, v196, v197
    v_cvt_pk_bf16_f32 v171, v198, v199
    ds_write_b128 v138, v[168:171] offset:8192
    s_waitcnt vmcnt(9)
    buffer_load_dwordx4 v[84:87], v252, s[4:7], s22 offen offset:64 nt
    v_lshlrev_b32 v200, 16, v172
    v_and_b32 v201, 0xffff0000, v172
    v_lshlrev_b32 v202, 16, v173
    v_and_b32 v203, 0xffff0000, v173
    v_lshlrev_b32 v204, 16, v174
    v_and_b32 v205, 0xffff0000, v174
    v_lshlrev_b32 v206, 16, v175
    v_and_b32 v207, 0xffff0000, v175
    v_mul_f32 v200, s27, v200
    v_mul_f32 v201, s27, v201
    v_mul_f32 v202, s27, v202
    v_mul_f32 v203, s27, v203
    v_mul_f32 v204, s27, v204
    v_mul_f32 v205, s27, v205
    v_mul_f32 v206, s27, v206
    v_mul_f32 v207, s27, v207
    v_cvt_pk_bf16_f32 v172, v200, v201
    v_cvt_pk_bf16_f32 v173, v202, v203
    v_cvt_pk_bf16_f32 v174, v204, v205
    v_cvt_pk_bf16_f32 v175, v206, v207
    ds_write_b128 v139, v[172:175] offset:8192
    s_waitcnt vmcnt(6)
    buffer_load_dwordx4 v[88:91], v252, s[4:7], s22 offen offset:128 nt
    buffer_load_dwordx4 v[92:95], v252, s[4:7], s22 offen offset:192 nt
    v_add_u32 v140, 0x10000, v140
    v_add_u32 v141, 0x10000, v141
    v_perm_b32 v128, v180, v176, s34
    v_perm_b32 v129, v188, v184, s34
    ds_write_b64 v140, v[128:129] offset:0
    v_perm_b32 v130, v180, v176, s35
    v_perm_b32 v131, v188, v184, s35
    ds_write_b64 v141, v[130:131] offset:0
    v_perm_b32 v132, v181, v177, s34
    v_perm_b32 v133, v189, v185, s34
    ds_write_b64 v140, v[132:133] offset:128
    v_perm_b32 v134, v181, v177, s35
    v_perm_b32 v135, v189, v185, s35
    ds_write_b64 v141, v[134:135] offset:128
    s_waitcnt lgkmcnt(0)
    s_barrier
    v_perm_b32 v128, v182, v178, s34
    v_perm_b32 v129, v190, v186, s34
    ds_write_b64 v140, v[128:129] offset:1024
    v_perm_b32 v130, v182, v178, s35
    v_perm_b32 v131, v190, v186, s35
    ds_write_b64 v141, v[130:131] offset:1024
    v_perm_b32 v132, v183, v179, s34
    v_perm_b32 v133, v191, v187, s34
    ds_write_b64 v140, v[132:133] offset:1152
    v_perm_b32 v134, v183, v179, s35
    v_perm_b32 v135, v191, v187, s35
    ds_write_b64 v141, v[134:135] offset:1152
    s_waitcnt lgkmcnt(0)
    s_barrier
    s_waitcnt vmcnt(0)
    s_branch L_b0
L_a2:
    v_lshrrev_b32 v131, 2, v128
    v_and_b32 v132, 3, v129
    s_mov_b32 s18, 41943040
    s_mov_b32 s19, 0x20000
    s_mov_b32 s29, 0x47800000
    s_add_u32 s23, s21, 0x10000
    s_add_u32 s24, s21, 0x11000
    s_add_u32 s25, s21, 0x20000
    s_add_u32 s26, s21, 0x21000
    v_lshrrev_b32 v249, 1, v131
    v_xor_b32 v135, v131, v249
    v_and_b32 v135, 1, v135
    v_lshl_add_u32 v135, v135, 1, v249
    v_xor_b32 v135, v135, v130
    v_lshl_add_u32 v135, v128, 2, v135
    v_lshlrev_b32 v248, 4, v135
    v_add_u32 v249, 0x10000, v248
    v_lshlrev_b32 v135, 8, v128
    v_lshl_add_u32 v252, v130, 4, v135
    v_and_b32 v135, 1, v130
    v_xor_b32 v135, v135, v132
    v_lshl_add_u32 v135, v135, 2, v131
    v_lshl_add_u32 v135, v130, 4, v135
    v_lshlrev_b32 v135, 4, v135
    v_add_u32 v250, 81920, v135
    v_add_u32 v251, 147456, v135
    v_mov_b32 v224, 0x3f803f80
    v_mov_b32 v225, 0x3f803f80
    v_mov_b32 v226, 0x3f803f80
    v_mov_b32 v227, 0x3f803f80
    v_lshl_add_u32 v212, v128, 8, v133
    v_add_u32 v212, s28, v212
    v_xor_b32 v213, 64, v212
    v_xor_b32 v214, 128, v212
    v_xor_b32 v215, 192, v212
    s_setprio 2
    s_waitcnt vmcnt(0)
    ds_read_b128 v[64:67], v212 offset:0
    ds_read_b128 v[68:71], v213 offset:0
    ds_read_b128 v[72:75], v214 offset:0
    ds_read_b128 v[76:79], v215 offset:0
    ds_read_b128 v[80:83], v212 offset:4096
    ds_read_b128 v[84:87], v213 offset:4096
    ds_read_b128 v[88:91], v214 offset:4096
    ds_read_b128 v[92:95], v215 offset:4096
    s_waitcnt lgkmcnt(0)
    s_barrier
    ds_read_b128 v[228:231], v248 offset:0
    ds_read_b128 v[232:235], v248 offset:1024
    ds_read_b128 v[236:239], v248 offset:2048
    ds_read_b128 v[240:243], v248 offset:3072
    s_waitcnt lgkmcnt(2)
    v_mfma_f32_16x16x32_bf16 v[160:163], v[228:231], v[64:67], 0
    v_mfma_f32_16x16x32_bf16 v[168:171], v[228:231], v[80:83], 0
    ds_read_b128 v[244:247], v248 offset:4096
    v_mfma_f32_16x16x32_bf16 v[160:163], v[232:235], v[68:71], v[160:163]
    v_mfma_f32_16x16x32_bf16 v[168:171], v[232:235], v[84:87], v[168:171]
    ds_read_b128 v[228:231], v248 offset:5120
    s_waitcnt lgkmcnt(2)
    v_mfma_f32_16x16x32_bf16 v[160:163], v[236:239], v[72:75], v[160:163]
    v_mfma_f32_16x16x32_bf16 v[168:171], v[236:239], v[88:91], v[168:171]
    ds_read_b128 v[232:235], v248 offset:6144
    v_mfma_f32_16x16x32_bf16 v[160:163], v[240:243], v[76:79], v[160:163]
    v_mfma_f32_16x16x32_bf16 v[168:171], v[240:243], v[92:95], v[168:171]
    ds_read_b128 v[236:239], v248 offset:7168
    s_waitcnt lgkmcnt(2)
    v_mfma_f32_16x16x32_bf16 v[164:167], v[244:247], v[64:67], 0
    v_mfma_f32_16x16x32_bf16 v[172:175], v[244:247], v[80:83], 0
    ds_read_b128 v[240:243], v248 offset:8192
    v_mfma_f32_16x16x32_bf16 v[164:167], v[228:231], v[68:71], v[164:167]
    s_nop 0
    v_max3_f32 v208, v160, v161, v162
    v_max3_f32 v212, v168, v169, v170
    v_mfma_f32_16x16x32_bf16 v[172:175], v[228:231], v[84:87], v[172:175]
    ds_read_b128 v[244:247], v248 offset:9216
    s_waitcnt lgkmcnt(2)
    v_mfma_f32_16x16x32_bf16 v[164:167], v[232:235], v[72:75], v[164:167]
    v_mfma_f32_16x16x32_bf16 v[172:175], v[232:235], v[88:91], v[172:175]
    ds_read_b128 v[228:231], v248 offset:10240
    v_mfma_f32_16x16x32_bf16 v[164:167], v[236:239], v[76:79], v[164:167]
    v_mfma_f32_16x16x32_bf16 v[172:175], v[236:239], v[92:95], v[172:175]
    ds_read_b128 v[232:235], v248 offset:11264
    s_waitcnt lgkmcnt(2)
    v_mfma_f32_16x16x32_bf16 v[176:179], v[240:243], v[64:67], 0
    v_mfma_f32_16x16x32_bf16 v[184:187], v[240:243], v[80:83], 0
    ds_read_b128 v[236:239], v248 offset:12288
    v_mfma_f32_16x16x32_bf16 v[176:179], v[244:247], v[68:71], v[176:179]
    s_nop 0
    v_max3_f32 v208, v163, v164, v208
    v_max3_f32 v212, v171, v172, v212
    v_max3_f32 v208, v165, v166, v208
    v_max3_f32 v212, v173, v174, v212
    v_max_f32 v208, v167, v208
    v_max_f32 v212, v175, v212
    s_nop 1
    v_permlane16_swap_b32 v208, v212
    v_mfma_f32_16x16x32_bf16 v[184:187], v[244:247], v[84:87], v[184:187]
    ds_read_b128 v[240:243], v248 offset:13312
    v_max_f32 v208, v208, v212
    v_mov_b32 v212, v208
    s_nop 1
    v_permlane32_swap_b32 v208, v212
    v_max_f32 v208, v208, v212
    v_mov_b32 v212, v208
    s_waitcnt lgkmcnt(2)
    v_mfma_f32_16x16x32_bf16 v[176:179], v[228:231], v[72:75], v[176:179]
    v_permlane16_swap_b32 v208, v212
    v_sub_f32 v209, 0, v208
    v_sub_f32 v210, 0, v208
    v_sub_f32 v211, 0, v208
    v_sub_f32 v208, 0, v208
    v_sub_f32 v213, 0, v212
    v_sub_f32 v214, 0, v212
    v_mfma_f32_16x16x32_bf16 v[184:187], v[228:231], v[88:91], v[184:187]
    ds_read_b128 v[244:247], v248 offset:14336
    v_sub_f32 v215, 0, v212
    v_sub_f32 v212, 0, v212
    v_add_f32 v160, v160, v208
    v_exp_f32 v160, v160
    v_add_f32 v161, v161, v208
    v_mfma_f32_16x16x32_bf16 v[176:179], v[232:235], v[76:79], v[176:179]
    v_exp_f32 v161, v161
    v_add_f32 v162, v162, v208
    v_exp_f32 v162, v162
    v_add_f32 v163, v163, v208
    v_add_f32 v168, v168, v212
    v_mfma_f32_16x16x32_bf16 v[184:187], v[232:235], v[92:95], v[184:187]
    ds_read_b128 v[228:231], v248 offset:15360
    v_cvt_pk_bf16_f32 v192, v160, v161
    v_exp_f32 v163, v163
    v_exp_f32 v168, v168
    s_waitcnt lgkmcnt(2)
    v_mfma_f32_16x16x32_bf16 v[180:183], v[236:239], v[64:67], 0
    v_cvt_pk_bf16_f32 v193, v162, v163
    v_add_f32 v169, v169, v212
    v_exp_f32 v169, v169
    v_add_f32 v170, v170, v212
    v_exp_f32 v170, v170
    v_mfma_f32_16x16x32_bf16 v[188:191], v[236:239], v[80:83], 0
    s_barrier
    ds_read_b128 v[232:235], v250 offset:0
    v_cvt_pk_bf16_f32 v196, v168, v169
    v_add_f32 v171, v171, v212
    v_exp_f32 v171, v171
    v_add_f32 v164, v164, v208
    v_add_f32 v165, v165, v208
    v_mfma_f32_16x16x32_bf16 v[180:183], v[240:243], v[68:71], v[180:183]
    v_exp_f32 v164, v164
    v_cvt_pk_bf16_f32 v197, v170, v171
    v_exp_f32 v165, v165
    v_add_f32 v166, v166, v208
    v_mfma_f32_16x16x32_bf16 v[188:191], v[240:243], v[84:87], v[188:191]
    ds_read_b128 v[236:239], v250 offset:1024
    v_cvt_pk_bf16_f32 v194, v164, v165
    v_exp_f32 v166, v166
    v_add_f32 v167, v167, v208
    s_waitcnt lgkmcnt(2)
    v_mfma_f32_16x16x32_bf16 v[180:183], v[244:247], v[72:75], v[180:183]
    v_exp_f32 v167, v167
    v_add_f32 v172, v172, v212
    v_exp_f32 v172, v172
    v_add_f32 v173, v173, v212
    v_mfma_f32_16x16x32_bf16 v[188:191], v[244:247], v[88:91], v[188:191]
    ds_read_b128 v[240:243], v250 offset:2048
    v_cvt_pk_bf16_f32 v195, v166, v167
    v_exp_f32 v173, v173
    v_add_f32 v174, v174, v212
    v_add_f32 v175, v175, v212
    v_mfma_f32_16x16x32_bf16 v[180:183], v[228:231], v[76:79], v[180:183]
    v_exp_f32 v174, v174
    v_cvt_pk_bf16_f32 v198, v172, v173
    v_exp_f32 v175, v175
    v_add_f32 v176, v176, v208
    v_mfma_f32_16x16x32_bf16 v[188:191], v[228:231], v[92:95], v[188:191]
    ds_read_b128 v[244:247], v250 offset:3072
    v_cvt_pk_bf16_f32 v199, v174, v175
    v_mfma_f32_16x16x32_bf16 v[216:219], v[224:227], v[192:195], 0
    v_exp_f32 v176, v176
    v_mfma_f32_16x16x32_bf16 v[220:223], v[224:227], v[196:199], 0
    s_waitcnt lgkmcnt(2)
    v_mfma_f32_16x16x32_bf16 v[0:3], v[232:235], v[192:195], 0
    v_add_f32 v177, v177, v208
    v_add_f32 v178, v178, v208
    v_add_f32 v179, v179, v208
    v_mfma_f32_16x16x32_bf16 v[32:35], v[232:235], v[196:199], 0
    ds_read_b128 v[228:231], v250 offset:4096
    v_add_f32 v184, v184, v212
    v_add_f32 v185, v185, v212
    v_mfma_f32_16x16x32_bf16 v[4:7], v[236:239], v[192:195], 0
    v_exp_f32 v177, v177
    v_add_f32 v186, v186, v212
    v_mfma_f32_16x16x32_bf16 v[36:39], v[236:239], v[196:199], 0
    ds_read_b128 v[232:235], v250 offset:5120
    v_cvt_pk_bf16_f32 v200, v176, v177
    s_waitcnt lgkmcnt(2)
    v_mfma_f32_16x16x32_bf16 v[8:11], v[240:243], v[192:195], 0
    v_exp_f32 v178, v178
    v_add_f32 v187, v187, v212
    v_mfma_f32_16x16x32_bf16 v[40:43], v[240:243], v[196:199], 0
    ds_read_b128 v[236:239], v250 offset:6144
    v_add_f32 v180, v180, v208
    v_add_f32 v181, v181, v208
    v_mfma_f32_16x16x32_bf16 v[12:15], v[244:247], v[192:195], 0
    v_exp_f32 v179, v179
    v_add_f32 v182, v182, v208
    v_mfma_f32_16x16x32_bf16 v[44:47], v[244:247], v[196:199], 0
    ds_read_b128 v[240:243], v250 offset:7168
    v_cvt_pk_bf16_f32 v201, v178, v179
    s_waitcnt lgkmcnt(2)
    v_mfma_f32_16x16x32_bf16 v[16:19], v[228:231], v[192:195], 0
    v_exp_f32 v184, v184
    v_add_f32 v183, v183, v208
    v_mfma_f32_16x16x32_bf16 v[48:51], v[228:231], v[196:199], 0
    ds_read_b128 v[244:247], v248 offset:16384
    v_add_f32 v188, v188, v212
    v_add_f32 v189, v189, v212
    v_mfma_f32_16x16x32_bf16 v[20:23], v[232:235], v[192:195], 0
    v_exp_f32 v185, v185
    v_add_f32 v190, v190, v212
    v_mfma_f32_16x16x32_bf16 v[52:55], v[232:235], v[196:199], 0
    ds_read_b128 v[228:231], v248 offset:17408
    v_cvt_pk_bf16_f32 v204, v184, v185
    s_waitcnt lgkmcnt(2)
    v_mfma_f32_16x16x32_bf16 v[24:27], v[236:239], v[192:195], 0
    v_exp_f32 v186, v186
    v_add_f32 v191, v191, v212
    v_mfma_f32_16x16x32_bf16 v[56:59], v[236:239], v[196:199], 0
    ds_read_b128 v[232:235], v248 offset:18432
    v_mfma_f32_16x16x32_bf16 v[28:31], v[240:243], v[192:195], 0
    v_exp_f32 v187, v187
    v_mfma_f32_16x16x32_bf16 v[60:63], v[240:243], v[196:199], 0
    ds_read_b128 v[236:239], v248 offset:19456
    v_cvt_pk_bf16_f32 v205, v186, v187
    s_waitcnt lgkmcnt(2)
    v_mfma_f32_16x16x32_bf16 v[160:163], v[244:247], v[64:67], v[208:211]
    v_exp_f32 v180, v180
    v_mfma_f32_16x16x32_bf16 v[168:171], v[244:247], v[80:83], v[212:215]
    ds_read_b128 v[240:243], v248 offset:20480
    v_mfma_f32_16x16x32_bf16 v[160:163], v[228:231], v[68:71], v[160:163]
    v_exp_f32 v181, v181
    v_mfma_f32_16x16x32_bf16 v[168:171], v[228:231], v[84:87], v[168:171]
    ds_read_b128 v[244:247], v248 offset:21504
    v_cvt_pk_bf16_f32 v202, v180, v181
    s_waitcnt lgkmcnt(2)
    v_mfma_f32_16x16x32_bf16 v[160:163], v[232:235], v[72:75], v[160:163]
    v_exp_f32 v182, v182
    v_mfma_f32_16x16x32_bf16 v[168:171], v[232:235], v[88:91], v[168:171]
    ds_read_b128 v[228:231], v248 offset:22528
    v_mfma_f32_16x16x32_bf16 v[160:163], v[236:239], v[76:79], v[160:163]
    v_exp_f32 v183, v183
    v_mfma_f32_16x16x32_bf16 v[168:171], v[236:239], v[92:95], v[168:171]
    ds_read_b128 v[232:235], v248 offset:23552
    v_cvt_pk_bf16_f32 v203, v182, v183
    s_waitcnt lgkmcnt(2)
    v_mfma_f32_16x16x32_bf16 v[164:167], v[240:243], v[64:67], v[208:211]
    v_exp_f32 v188, v188
    v_mfma_f32_16x16x32_bf16 v[172:175], v[240:243], v[80:83], v[212:215]
    s_barrier
    ds_read_b128 v[236:239], v250 offset:8192
    v_mfma_f32_16x16x32_bf16 v[164:167], v[244:247], v[68:71], v[164:167]
    v_exp_f32 v189, v189
    v_mfma_f32_16x16x32_bf16 v[172:175], v[244:247], v[84:87], v[172:175]
    ds_read_b128 v[240:243], v250 offset:9216
    v_cvt_pk_bf16_f32 v206, v188, v189
    s_waitcnt lgkmcnt(2)
    v_mfma_f32_16x16x32_bf16 v[164:167], v[228:231], v[72:75], v[164:167]
    v_exp_f32 v190, v190
    v_mfma_f32_16x16x32_bf16 v[172:175], v[228:231], v[88:91], v[172:175]
    ds_read_b128 v[244:247], v250 offset:10240
    v_mfma_f32_16x16x32_bf16 v[164:167], v[232:235], v[76:79], v[164:167]
    v_exp_f32 v191, v191
    v_mfma_f32_16x16x32_bf16 v[172:175], v[232:235], v[92:95], v[172:175]
    ds_read_b128 v[228:231], v250 offset:11264
    v_cvt_pk_bf16_f32 v207, v190, v191
    v_mfma_f32_16x16x32_bf16 v[216:219], v[224:227], v[200:203], v[216:219]
    v_exp_f32 v160, v160
    v_mfma_f32_16x16x32_bf16 v[220:223], v[224:227], v[204:207], v[220:223]
    s_waitcnt lgkmcnt(2)
    v_mfma_f32_16x16x32_bf16 v[0:3], v[236:239], v[200:203], v[0:3]
    v_exp_f32 v161, v161
    v_mfma_f32_16x16x32_bf16 v[32:35], v[236:239], v[204:207], v[32:35]
    ds_read_b128 v[232:235], v250 offset:12288
    v_cvt_pk_bf16_f32 v192, v160, v161
    v_mfma_f32_16x16x32_bf16 v[4:7], v[240:243], v[200:203], v[4:7]
    v_exp_f32 v162, v162
    v_mfma_f32_16x16x32_bf16 v[36:39], v[240:243], v[204:207], v[36:39]
    ds_read_b128 v[236:239], v250 offset:13312
    s_waitcnt lgkmcnt(2)
    v_mfma_f32_16x16x32_bf16 v[8:11], v[244:247], v[200:203], v[8:11]
    v_exp_f32 v163, v163
    v_mfma_f32_16x16x32_bf16 v[40:43], v[244:247], v[204:207], v[40:43]
    ds_read_b128 v[240:243], v250 offset:14336
    v_cvt_pk_bf16_f32 v193, v162, v163
    v_mfma_f32_16x16x32_bf16 v[12:15], v[228:231], v[200:203], v[12:15]
    v_exp_f32 v168, v168
    v_mfma_f32_16x16x32_bf16 v[44:47], v[228:231], v[204:207], v[44:47]
    ds_read_b128 v[244:247], v250 offset:15360
    s_waitcnt lgkmcnt(2)
    v_mfma_f32_16x16x32_bf16 v[16:19], v[232:235], v[200:203], v[16:19]
    v_exp_f32 v169, v169
    v_mfma_f32_16x16x32_bf16 v[48:51], v[232:235], v[204:207], v[48:51]
    ds_read_b128 v[228:231], v248 offset:24576
    v_cvt_pk_bf16_f32 v196, v168, v169
    v_mfma_f32_16x16x32_bf16 v[20:23], v[236:239], v[200:203], v[20:23]
    v_exp_f32 v170, v170
    v_mfma_f32_16x16x32_bf16 v[52:55], v[236:239], v[204:207], v[52:55]
    ds_read_b128 v[232:235], v248 offset:25600
    s_waitcnt lgkmcnt(2)
    v_mfma_f32_16x16x32_bf16 v[24:27], v[240:243], v[200:203], v[24:27]
    v_exp_f32 v171, v171
    v_mfma_f32_16x16x32_bf16 v[56:59], v[240:243], v[204:207], v[56:59]
    ds_read_b128 v[236:239], v248 offset:26624
    v_cvt_pk_bf16_f32 v197, v170, v171
    v_mfma_f32_16x16x32_bf16 v[28:31], v[244:247], v[200:203], v[28:31]
    v_exp_f32 v164, v164
    v_mfma_f32_16x16x32_bf16 v[60:63], v[244:247], v[204:207], v[60:63]
    ds_read_b128 v[240:243], v248 offset:27648
    s_waitcnt lgkmcnt(2)
    v_mfma_f32_16x16x32_bf16 v[176:179], v[228:231], v[64:67], v[208:211]
    v_exp_f32 v165, v165
    v_mfma_f32_16x16x32_bf16 v[184:187], v[228:231], v[80:83], v[212:215]
    ds_read_b128 v[244:247], v248 offset:28672
    v_cvt_pk_bf16_f32 v194, v164, v165
    v_mfma_f32_16x16x32_bf16 v[176:179], v[232:235], v[68:71], v[176:179]
    v_exp_f32 v166, v166
    v_mfma_f32_16x16x32_bf16 v[184:187], v[232:235], v[84:87], v[184:187]
    ds_read_b128 v[228:231], v248 offset:29696
    s_waitcnt lgkmcnt(2)
    v_mfma_f32_16x16x32_bf16 v[176:179], v[236:239], v[72:75], v[176:179]
    v_exp_f32 v167, v167
    v_mfma_f32_16x16x32_bf16 v[184:187], v[236:239], v[88:91], v[184:187]
    ds_read_b128 v[232:235], v248 offset:30720
    v_cvt_pk_bf16_f32 v195, v166, v167
    v_mfma_f32_16x16x32_bf16 v[176:179], v[240:243], v[76:79], v[176:179]
    v_exp_f32 v172, v172
    v_mfma_f32_16x16x32_bf16 v[184:187], v[240:243], v[92:95], v[184:187]
    ds_read_b128 v[236:239], v248 offset:31744
    s_waitcnt lgkmcnt(2)
    v_mfma_f32_16x16x32_bf16 v[180:183], v[244:247], v[64:67], v[208:211]
    v_exp_f32 v173, v173
    v_mfma_f32_16x16x32_bf16 v[188:191], v[244:247], v[80:83], v[212:215]
    s_barrier
    ds_read_b128 v[240:243], v250 offset:16384
    v_cvt_pk_bf16_f32 v198, v172, v173
    v_mfma_f32_16x16x32_bf16 v[180:183], v[228:231], v[68:71], v[180:183]
    v_exp_f32 v174, v174
    v_mfma_f32_16x16x32_bf16 v[188:191], v[228:231], v[84:87], v[188:191]
    ds_read_b128 v[244:247], v250 offset:17408
    s_waitcnt lgkmcnt(2)
    v_mfma_f32_16x16x32_bf16 v[180:183], v[232:235], v[72:75], v[180:183]
    v_exp_f32 v175, v175
    v_mfma_f32_16x16x32_bf16 v[188:191], v[232:235], v[88:91], v[188:191]
    ds_read_b128 v[228:231], v250 offset:18432
    v_cvt_pk_bf16_f32 v199, v174, v175
    v_mfma_f32_16x16x32_bf16 v[180:183], v[236:239], v[76:79], v[180:183]
    v_exp_f32 v176, v176
    v_mfma_f32_16x16x32_bf16 v[188:191], v[236:239], v[92:95], v[188:191]
    ds_read_b128 v[232:235], v250 offset:19456
    v_mfma_f32_16x16x32_bf16 v[216:219], v[224:227], v[192:195], v[216:219]
    v_exp_f32 v177, v177
    v_mfma_f32_16x16x32_bf16 v[220:223], v[224:227], v[196:199], v[220:223]
    s_waitcnt lgkmcnt(2)
    v_mfma_f32_16x16x32_bf16 v[0:3], v[240:243], v[192:195], v[0:3]
    v_exp_f32 v178, v178
    v_mfma_f32_16x16x32_bf16 v[32:35], v[240:243], v[196:199], v[32:35]
    ds_read_b128 v[236:239], v250 offset:20480
    v_cvt_pk_bf16_f32 v200, v176, v177
    v_mfma_f32_16x16x32_bf16 v[4:7], v[244:247], v[192:195], v[4:7]
    v_exp_f32 v179, v179
    v_mfma_f32_16x16x32_bf16 v[36:39], v[244:247], v[196:199], v[36:39]
    ds_read_b128 v[240:243], v250 offset:21504
    s_waitcnt lgkmcnt(2)
    v_mfma_f32_16x16x32_bf16 v[8:11], v[228:231], v[192:195], v[8:11]
    v_exp_f32 v184, v184
    v_mfma_f32_16x16x32_bf16 v[40:43], v[228:231], v[196:199], v[40:43]
    ds_read_b128 v[244:247], v250 offset:22528
    v_cvt_pk_bf16_f32 v201, v178, v179
    v_mfma_f32_16x16x32_bf16 v[12:15], v[232:235], v[192:195], v[12:15]
    v_exp_f32 v185, v185
    v_mfma_f32_16x16x32_bf16 v[44:47], v[232:235], v[196:199], v[44:47]
    ds_read_b128 v[228:231], v250 offset:23552
    s_waitcnt lgkmcnt(2)
    v_mfma_f32_16x16x32_bf16 v[16:19], v[236:239], v[192:195], v[16:19]
    v_exp_f32 v186, v186
    v_mfma_f32_16x16x32_bf16 v[48:51], v[236:239], v[196:199], v[48:51]
    ds_read_b128 v[232:235], v248 offset:32768
    v_cvt_pk_bf16_f32 v204, v184, v185
    v_mfma_f32_16x16x32_bf16 v[20:23], v[240:243], v[192:195], v[20:23]
    v_exp_f32 v187, v187
    v_mfma_f32_16x16x32_bf16 v[52:55], v[240:243], v[196:199], v[52:55]
    ds_read_b128 v[236:239], v248 offset:33792
    s_waitcnt lgkmcnt(2)
    v_mfma_f32_16x16x32_bf16 v[24:27], v[244:247], v[192:195], v[24:27]
    v_exp_f32 v180, v180
    v_mfma_f32_16x16x32_bf16 v[56:59], v[244:247], v[196:199], v[56:59]
    ds_read_b128 v[240:243], v248 offset:34816
    v_cvt_pk_bf16_f32 v205, v186, v187
    v_mfma_f32_16x16x32_bf16 v[28:31], v[228:231], v[192:195], v[28:31]
    v_exp_f32 v181, v181
    v_mfma_f32_16x16x32_bf16 v[60:63], v[228:231], v[196:199], v[60:63]
    ds_read_b128 v[244:247], v248 offset:35840
    s_waitcnt lgkmcnt(2)
    v_mfma_f32_16x16x32_bf16 v[160:163], v[232:235], v[64:67], v[208:211]
    v_exp_f32 v182, v182
    v_mfma_f32_16x16x32_bf16 v[168:171], v[232:235], v[80:83], v[212:215]
    ds_read_b128 v[228:231], v248 offset:36864
    v_cvt_pk_bf16_f32 v202, v180, v181
    v_mfma_f32_16x16x32_bf16 v[160:163], v[236:239], v[68:71], v[160:163]
    v_exp_f32 v183, v183
    v_mfma_f32_16x16x32_bf16 v[168:171], v[236:239], v[84:87], v[168:171]
    ds_read_b128 v[232:235], v248 offset:37888
    s_waitcnt lgkmcnt(2)
    v_mfma_f32_16x16x32_bf16 v[160:163], v[240:243], v[72:75], v[160:163]
    v_exp_f32 v188, v188
    v_mfma_f32_16x16x32_bf16 v[168:171], v[240:243], v[88:91], v[168:171]
    ds_read_b128 v[236:239], v248 offset:38912
    v_cvt_pk_bf16_f32 v203, v182, v183
    v_mfma_f32_16x16x32_bf16 v[160:163], v[244:247], v[76:79], v[160:163]
    v_exp_f32 v189, v189
    v_mfma_f32_16x16x32_bf16 v[168:171], v[244:247], v[92:95], v[168:171]
    ds_read_b128 v[240:243], v248 offset:39936
    s_waitcnt lgkmcnt(2)
    v_mfma_f32_16x16x32_bf16 v[164:167], v[228:231], v[64:67], v[208:211]
    v_exp_f32 v190, v190
    v_mfma_f32_16x16x32_bf16 v[172:175], v[228:231], v[80:83], v[212:215]
    s_barrier
    ds_read_b128 v[244:247], v250 offset:24576
    v_cvt_pk_bf16_f32 v206, v188, v189
    v_mfma_f32_16x16x32_bf16 v[164:167], v[232:235], v[68:71], v[164:167]
    v_exp_f32 v191, v191
    v_mfma_f32_16x16x32_bf16 v[172:175], v[232:235], v[84:87], v[172:175]
    ds_read_b128 v[228:231], v250 offset:25600
    s_waitcnt lgkmcnt(2)
    v_mfma_f32_16x16x32_bf16 v[164:167], v[236:239], v[72:75], v[164:167]
    v_exp_f32 v160, v160
    v_mfma_f32_16x16x32_bf16 v[172:175], v[236:239], v[88:91], v[172:175]
    ds_read_b128 v[232:235], v250 offset:26624
    v_cvt_pk_bf16_f32 v207, v190, v191
    v_mfma_f32_16x16x32_bf16 v[164:167], v[240:243], v[76:79], v[164:167]
    v_exp_f32 v161, v161
    v_mfma_f32_16x16x32_bf16 v[172:175], v[240:243], v[92:95], v[172:175]
    ds_read_b128 v[236:239], v250 offset:27648
    v_mfma_f32_16x16x32_bf16 v[216:219], v[224:227], v[200:203], v[216:219]
    v_exp_f32 v162, v162
    v_mfma_f32_16x16x32_bf16 v[220:223], v[224:227], v[204:207], v[220:223]
    s_waitcnt lgkmcnt(2)
    v_mfma_f32_16x16x32_bf16 v[0:3], v[244:247], v[200:203], v[0:3]
    v_exp_f32 v163, v163
    v_mfma_f32_16x16x32_bf16 v[32:35], v[244:247], v[204:207], v[32:35]
    ds_read_b128 v[240:243], v250 offset:28672
    v_cvt_pk_bf16_f32 v192, v160, v161
    v_mfma_f32_16x16x32_bf16 v[4:7], v[228:231], v[200:203], v[4:7]
    v_exp_f32 v168, v168
    v_mfma_f32_16x16x32_bf16 v[36:39], v[228:231], v[204:207], v[36:39]
    ds_read_b128 v[244:247], v250 offset:29696
    s_waitcnt lgkmcnt(2)
    v_mfma_f32_16x16x32_bf16 v[8:11], v[232:235], v[200:203], v[8:11]
    v_exp_f32 v169, v169
    v_mfma_f32_16x16x32_bf16 v[40:43], v[232:235], v[204:207], v[40:43]
    ds_read_b128 v[228:231], v250 offset:30720
    v_cvt_pk_bf16_f32 v193, v162, v163
    v_mfma_f32_16x16x32_bf16 v[12:15], v[236:239], v[200:203], v[12:15]
    v_exp_f32 v170, v170
    v_mfma_f32_16x16x32_bf16 v[44:47], v[236:239], v[204:207], v[44:47]
    ds_read_b128 v[232:235], v250 offset:31744
    s_waitcnt lgkmcnt(2)
    v_mfma_f32_16x16x32_bf16 v[16:19], v[240:243], v[200:203], v[16:19]
    v_exp_f32 v171, v171
    v_mfma_f32_16x16x32_bf16 v[48:51], v[240:243], v[204:207], v[48:51]
    ds_read_b128 v[236:239], v248 offset:40960
    v_cvt_pk_bf16_f32 v196, v168, v169
    v_mfma_f32_16x16x32_bf16 v[20:23], v[244:247], v[200:203], v[20:23]
    v_exp_f32 v164, v164
    v_mfma_f32_16x16x32_bf16 v[52:55], v[244:247], v[204:207], v[52:55]
    ds_read_b128 v[240:243], v248 offset:41984
    s_waitcnt lgkmcnt(2)
    v_mfma_f32_16x16x32_bf16 v[24:27], v[228:231], v[200:203], v[24:27]
    v_exp_f32 v165, v165
    v_mfma_f32_16x16x32_bf16 v[56:59], v[228:231], v[204:207], v[56:59]
    ds_read_b128 v[244:247], v248 offset:43008
    v_cvt_pk_bf16_f32 v197, v170, v171
    v_mfma_f32_16x16x32_bf16 v[28:31], v[232:235], v[200:203], v[28:31]
    v_exp_f32 v166, v166
    v_mfma_f32_16x16x32_bf16 v[60:63], v[232:235], v[204:207], v[60:63]
    ds_read_b128 v[228:231], v248 offset:44032
    s_waitcnt lgkmcnt(2)
    v_mfma_f32_16x16x32_bf16 v[176:179], v[236:239], v[64:67], v[208:211]
    v_exp_f32 v167, v167
    v_mfma_f32_16x16x32_bf16 v[184:187], v[236:239], v[80:83], v[212:215]
    ds_read_b128 v[232:235], v248 offset:45056
    v_cvt_pk_bf16_f32 v194, v164, v165
    v_mfma_f32_16x16x32_bf16 v[176:179], v[240:243], v[68:71], v[176:179]
    v_exp_f32 v172, v172
    v_mfma_f32_16x16x32_bf16 v[184:187], v[240:243], v[84:87], v[184:187]
    ds_read_b128 v[236:239], v248 offset:46080
    s_waitcnt lgkmcnt(2)
    v_mfma_f32_16x16x32_bf16 v[176:179], v[244:247], v[72:75], v[176:179]
    v_exp_f32 v173, v173
    v_mfma_f32_16x16x32_bf16 v[184:187], v[244:247], v[88:91], v[184:187]
    ds_read_b128 v[240:243], v248 offset:47104
    v_cvt_pk_bf16_f32 v195, v166, v167
    v_mfma_f32_16x16x32_bf16 v[176:179], v[228:231], v[76:79], v[176:179]
    v_exp_f32 v174, v174
    v_mfma_f32_16x16x32_bf16 v[184:187], v[228:231], v[92:95], v[184:187]
    ds_read_b128 v[244:247], v248 offset:48128
    s_waitcnt lgkmcnt(2)
    v_mfma_f32_16x16x32_bf16 v[180:183], v[232:235], v[64:67], v[208:211]
    v_exp_f32 v175, v175
    v_mfma_f32_16x16x32_bf16 v[188:191], v[232:235], v[80:83], v[212:215]
    s_barrier
    ds_read_b128 v[228:231], v250 offset:32768
    v_cvt_pk_bf16_f32 v198, v172, v173
    v_mfma_f32_16x16x32_bf16 v[180:183], v[236:239], v[68:71], v[180:183]
    v_exp_f32 v176, v176
    v_mfma_f32_16x16x32_bf16 v[188:191], v[236:239], v[84:87], v[188:191]
    ds_read_b128 v[232:235], v250 offset:33792
    s_waitcnt lgkmcnt(2)
    v_mfma_f32_16x16x32_bf16 v[180:183], v[240:243], v[72:75], v[180:183]
    v_exp_f32 v177, v177
    v_mfma_f32_16x16x32_bf16 v[188:191], v[240:243], v[88:91], v[188:191]
    ds_read_b128 v[236:239], v250 offset:34816
    v_cvt_pk_bf16_f32 v199, v174, v175
    v_mfma_f32_16x16x32_bf16 v[180:183], v[244:247], v[76:79], v[180:183]
    v_exp_f32 v178, v178
    v_mfma_f32_16x16x32_bf16 v[188:191], v[244:247], v[92:95], v[188:191]
    ds_read_b128 v[240:243], v250 offset:35840
    v_mfma_f32_16x16x32_bf16 v[216:219], v[224:227], v[192:195], v[216:219]
    v_exp_f32 v179, v179
    v_mfma_f32_16x16x32_bf16 v[220:223], v[224:227], v[196:199], v[220:223]
    s_waitcnt lgkmcnt(2)
    v_mfma_f32_16x16x32_bf16 v[0:3], v[228:231], v[192:195], v[0:3]
    v_exp_f32 v184, v184
    v_mfma_f32_16x16x32_bf16 v[32:35], v[228:231], v[196:199], v[32:35]
    ds_read_b128 v[244:247], v250 offset:36864
    v_cvt_pk_bf16_f32 v200, v176, v177
    v_mfma_f32_16x16x32_bf16 v[4:7], v[232:235], v[192:195], v[4:7]
    v_exp_f32 v185, v185
    v_mfma_f32_16x16x32_bf16 v[36:39], v[232:235], v[196:199], v[36:39]
    ds_read_b128 v[228:231], v250 offset:37888
    s_waitcnt lgkmcnt(2)
    v_mfma_f32_16x16x32_bf16 v[8:11], v[236:239], v[192:195], v[8:11]
    v_exp_f32 v186, v186
    v_mfma_f32_16x16x32_bf16 v[40:43], v[236:239], v[196:199], v[40:43]
    ds_read_b128 v[232:235], v250 offset:38912
    v_cvt_pk_bf16_f32 v201, v178, v179
    v_mfma_f32_16x16x32_bf16 v[12:15], v[240:243], v[192:195], v[12:15]
    v_exp_f32 v187, v187
    v_mfma_f32_16x16x32_bf16 v[44:47], v[240:243], v[196:199], v[44:47]
    ds_read_b128 v[236:239], v250 offset:39936
    s_waitcnt lgkmcnt(2)
    v_mfma_f32_16x16x32_bf16 v[16:19], v[244:247], v[192:195], v[16:19]
    v_exp_f32 v180, v180
    v_mfma_f32_16x16x32_bf16 v[48:51], v[244:247], v[196:199], v[48:51]
    ds_read_b128 v[240:243], v248 offset:49152
    v_cvt_pk_bf16_f32 v204, v184, v185
    v_mfma_f32_16x16x32_bf16 v[20:23], v[228:231], v[192:195], v[20:23]
    v_exp_f32 v181, v181
    v_mfma_f32_16x16x32_bf16 v[52:55], v[228:231], v[196:199], v[52:55]
    ds_read_b128 v[244:247], v248 offset:50176
    s_waitcnt lgkmcnt(2)
    v_mfma_f32_16x16x32_bf16 v[24:27], v[232:235], v[192:195], v[24:27]
    v_exp_f32 v182, v182
    v_mfma_f32_16x16x32_bf16 v[56:59], v[232:235], v[196:199], v[56:59]
    ds_read_b128 v[228:231], v248 offset:51200
    v_cvt_pk_bf16_f32 v205, v186, v187
    v_mfma_f32_16x16x32_bf16 v[28:31], v[236:239], v[192:195], v[28:31]
    v_exp_f32 v183, v183
    v_mfma_f32_16x16x32_bf16 v[60:63], v[236:239], v[196:199], v[60:63]
    ds_read_b128 v[232:235], v248 offset:52224
    s_waitcnt lgkmcnt(2)
    v_mfma_f32_16x16x32_bf16 v[160:163], v[240:243], v[64:67], v[208:211]
    v_exp_f32 v188, v188
    v_mfma_f32_16x16x32_bf16 v[168:171], v[240:243], v[80:83], v[212:215]
    ds_read_b128 v[236:239], v248 offset:53248
    v_cvt_pk_bf16_f32 v202, v180, v181
    v_mfma_f32_16x16x32_bf16 v[160:163], v[244:247], v[68:71], v[160:163]
    v_exp_f32 v189, v189
    v_mfma_f32_16x16x32_bf16 v[168:171], v[244:247], v[84:87], v[168:171]
    ds_read_b128 v[240:243], v248 offset:54272
    s_waitcnt lgkmcnt(2)
    v_mfma_f32_16x16x32_bf16 v[160:163], v[228:231], v[72:75], v[160:163]
    v_exp_f32 v190, v190
    v_mfma_f32_16x16x32_bf16 v[168:171], v[228:231], v[88:91], v[168:171]
    ds_read_b128 v[244:247], v248 offset:55296
    v_cvt_pk_bf16_f32 v203, v182, v183
    v_mfma_f32_16x16x32_bf16 v[160:163], v[232:235], v[76:79], v[160:163]
    v_exp_f32 v191, v191
    v_mfma_f32_16x16x32_bf16 v[168:171], v[232:235], v[92:95], v[168:171]
    ds_read_b128 v[228:231], v248 offset:56320
    s_waitcnt lgkmcnt(2)
    v_mfma_f32_16x16x32_bf16 v[164:167], v[236:239], v[64:67], v[208:211]
    v_cvt_pk_bf16_f32 v206, v188, v189
    v_cvt_pk_bf16_f32 v207, v190, v191
    v_mfma_f32_16x16x32_bf16 v[172:175], v[236:239], v[80:83], v[212:215]
    s_barrier
    ds_read_b128 v[232:235], v250 offset:40960
    v_mfma_f32_16x16x32_bf16 v[164:167], v[240:243], v[68:71], v[164:167]
    v_exp_f32 v160, v160
    v_mfma_f32_16x16x32_bf16 v[172:175], v[240:243], v[84:87], v[172:175]
    ds_read_b128 v[236:239], v250 offset:41984
    s_waitcnt lgkmcnt(2)
    v_mfma_f32_16x16x32_bf16 v[164:167], v[244:247], v[72:75], v[164:167]
    v_exp_f32 v161, v161
    v_mfma_f32_16x16x32_bf16 v[172:175], v[244:247], v[88:91], v[172:175]
    ds_read_b128 v[240:243], v250 offset:43008
    v_cvt_pk_bf16_f32 v192, v160, v161
    v_mfma_f32_16x16x32_bf16 v[164:167], v[228:231], v[76:79], v[164:167]
    v_exp_f32 v162, v162
    v_mfma_f32_16x16x32_bf16 v[172:175], v[228:231], v[92:95], v[172:175]
    ds_read_b128 v[244:247], v250 offset:44032
    v_mfma_f32_16x16x32_bf16 v[216:219], v[224:227], v[200:203], v[216:219]
    v_exp_f32 v163, v163
    v_mfma_f32_16x16x32_bf16 v[220:223], v[224:227], v[204:207], v[220:223]
    s_waitcnt lgkmcnt(2)
    v_mfma_f32_16x16x32_bf16 v[0:3], v[232:235], v[200:203], v[0:3]
    v_exp_f32 v168, v168
    v_mfma_f32_16x16x32_bf16 v[32:35], v[232:235], v[204:207], v[32:35]
    ds_read_b128 v[228:231], v250 offset:45056
    v_cvt_pk_bf16_f32 v193, v162, v163
    v_mfma_f32_16x16x32_bf16 v[4:7], v[236:239], v[200:203], v[4:7]
    v_exp_f32 v169, v169
    v_mfma_f32_16x16x32_bf16 v[36:39], v[236:239], v[204:207], v[36:39]
    ds_read_b128 v[232:235], v250 offset:46080
    s_waitcnt lgkmcnt(2)
    v_mfma_f32_16x16x32_bf16 v[8:11], v[240:243], v[200:203], v[8:11]
    v_exp_f32 v170, v170
    v_mfma_f32_16x16x32_bf16 v[40:43], v[240:243], v[204:207], v[40:43]
    ds_read_b128 v[236:239], v250 offset:47104
    v_cvt_pk_bf16_f32 v196, v168, v169
    v_mfma_f32_16x16x32_bf16 v[12:15], v[244:247], v[200:203], v[12:15]
    v_exp_f32 v171, v171
    v_mfma_f32_16x16x32_bf16 v[44:47], v[244:247], v[204:207], v[44:47]
    ds_read_b128 v[240:243], v250 offset:48128
    s_waitcnt lgkmcnt(2)
    v_mfma_f32_16x16x32_bf16 v[16:19], v[228:231], v[200:203], v[16:19]
    v_exp_f32 v164, v164
    v_mfma_f32_16x16x32_bf16 v[48:51], v[228:231], v[204:207], v[48:51]
    ds_read_b128 v[244:247], v248 offset:57344
    v_cvt_pk_bf16_f32 v197, v170, v171
    v_mfma_f32_16x16x32_bf16 v[20:23], v[232:235], v[200:203], v[20:23]
    v_exp_f32 v165, v165
    v_mfma_f32_16x16x32_bf16 v[52:55], v[232:235], v[204:207], v[52:55]
    ds_read_b128 v[228:231], v248 offset:58368
    s_waitcnt lgkmcnt(2)
    v_mfma_f32_16x16x32_bf16 v[24:27], v[236:239], v[200:203], v[24:27]
    v_exp_f32 v166, v166
    v_mfma_f32_16x16x32_bf16 v[56:59], v[236:239], v[204:207], v[56:59]
    ds_read_b128 v[232:235], v248 offset:59392
    v_cvt_pk_bf16_f32 v194, v164, v165
    v_mfma_f32_16x16x32_bf16 v[28:31], v[240:243], v[200:203], v[28:31]
    v_exp_f32 v167, v167
    v_mfma_f32_16x16x32_bf16 v[60:63], v[240:243], v[204:207], v[60:63]
    ds_read_b128 v[236:239], v248 offset:60416
    s_waitcnt lgkmcnt(2)
    v_mfma_f32_16x16x32_bf16 v[176:179], v[244:247], v[64:67], v[208:211]
    v_exp_f32 v172, v172
    v_mfma_f32_16x16x32_bf16 v[184:187], v[244:247], v[80:83], v[212:215]
    ds_read_b128 v[240:243], v248 offset:61440
    v_cvt_pk_bf16_f32 v195, v166, v167
    v_mfma_f32_16x16x32_bf16 v[176:179], v[228:231], v[68:71], v[176:179]
    v_exp_f32 v173, v173
    v_mfma_f32_16x16x32_bf16 v[184:187], v[228:231], v[84:87], v[184:187]
    ds_read_b128 v[244:247], v248 offset:62464
    s_waitcnt lgkmcnt(2)
    v_mfma_f32_16x16x32_bf16 v[176:179], v[232:235], v[72:75], v[176:179]
    v_exp_f32 v174, v174
    v_mfma_f32_16x16x32_bf16 v[184:187], v[232:235], v[88:91], v[184:187]
    ds_read_b128 v[228:231], v248 offset:63488
    v_cvt_pk_bf16_f32 v198, v172, v173
    v_mfma_f32_16x16x32_bf16 v[176:179], v[236:239], v[76:79], v[176:179]
    v_exp_f32 v175, v175
    v_mfma_f32_16x16x32_bf16 v[184:187], v[236:239], v[92:95], v[184:187]
    ds_read_b128 v[232:235], v248 offset:64512
    s_waitcnt lgkmcnt(2)
    v_mfma_f32_16x16x32_bf16 v[180:183], v[240:243], v[64:67], v[208:211]
    v_cvt_pk_bf16_f32 v199, v174, v175
    v_mfma_f32_16x16x32_bf16 v[188:191], v[240:243], v[80:83], v[212:215]
    s_barrier
    ds_read_b128 v[236:239], v250 offset:49152
    v_mfma_f32_16x16x32_bf16 v[180:183], v[244:247], v[68:71], v[180:183]
    v_exp_f32 v176, v176
    v_mfma_f32_16x16x32_bf16 v[188:191], v[244:247], v[84:87], v[188:191]
    ds_read_b128 v[240:243], v250 offset:50176
    s_waitcnt lgkmcnt(2)
    v_mfma_f32_16x16x32_bf16 v[180:183], v[228:231], v[72:75], v[180:183]
    v_exp_f32 v177, v177
    v_mfma_f32_16x16x32_bf16 v[188:191], v[228:231], v[88:91], v[188:191]
    ds_read_b128 v[244:247], v250 offset:51200
    buffer_load_dwordx4 v[96:99], v252, s[4:7], s23 offen offset:0 nt
    v_mfma_f32_16x16x32_bf16 v[180:183], v[232:235], v[76:79], v[180:183]
    v_exp_f32 v178, v178
    v_mfma_f32_16x16x32_bf16 v[188:191], v[232:235], v[92:95], v[188:191]
    ds_read_b128 v[228:231], v250 offset:52224
    v_mfma_f32_16x16x32_bf16 v[216:219], v[224:227], v[192:195], v[216:219]
    v_exp_f32 v179, v179
    v_mfma_f32_16x16x32_bf16 v[220:223], v[224:227], v[196:199], v[220:223]
    s_waitcnt lgkmcnt(2)
    v_mfma_f32_16x16x32_bf16 v[0:3], v[236:239], v[192:195], v[0:3]
    v_exp_f32 v184, v184
    v_mfma_f32_16x16x32_bf16 v[32:35], v[236:239], v[196:199], v[32:35]
    ds_read_b128 v[232:235], v250 offset:53248
    v_cvt_pk_bf16_f32 v200, v176, v177
    v_mfma_f32_16x16x32_bf16 v[4:7], v[240:243], v[192:195], v[4:7]
    v_exp_f32 v185, v185
    v_mfma_f32_16x16x32_bf16 v[36:39], v[240:243], v[196:199], v[36:39]
    ds_read_b128 v[236:239], v250 offset:54272
    s_waitcnt lgkmcnt(2)
    v_mfma_f32_16x16x32_bf16 v[8:11], v[244:247], v[192:195], v[8:11]
    v_exp_f32 v186, v186
    v_mfma_f32_16x16x32_bf16 v[40:43], v[244:247], v[196:199], v[40:43]
    ds_read_b128 v[240:243], v250 offset:55296
    v_cvt_pk_bf16_f32 v201, v178, v179
    v_mfma_f32_16x16x32_bf16 v[12:15], v[228:231], v[192:195], v[12:15]
    v_exp_f32 v187, v187
    v_mfma_f32_16x16x32_bf16 v[44:47], v[228:231], v[196:199], v[44:47]
    ds_read_b128 v[244:247], v250 offset:56320
    buffer_load_dwordx4 v[100:103], v252, s[4:7], s23 offen offset:64 nt
    s_waitcnt lgkmcnt(2)
    v_mfma_f32_16x16x32_bf16 v[16:19], v[232:235], v[192:195], v[16:19]
    v_exp_f32 v180, v180
    v_mfma_f32_16x16x32_bf16 v[48:51], v[232:235], v[196:199], v[48:51]
    ds_read_b128 v[228:231], v249 offset:0
    v_cvt_pk_bf16_f32 v204, v184, v185
    v_mfma_f32_16x16x32_bf16 v[20:23], v[236:239], v[192:195], v[20:23]
    v_exp_f32 v181, v181
    v_mfma_f32_16x16x32_bf16 v[52:55], v[236:239], v[196:199], v[52:55]
    ds_read_b128 v[232:235], v249 offset:1024
    s_waitcnt lgkmcnt(2)
    v_mfma_f32_16x16x32_bf16 v[24:27], v[240:243], v[192:195], v[24:27]
    v_exp_f32 v182, v182
    v_mfma_f32_16x16x32_bf16 v[56:59], v[240:243], v[196:199], v[56:59]
    ds_read_b128 v[236:239], v249 offset:2048
    v_cvt_pk_bf16_f32 v205, v186, v187
    v_mfma_f32_16x16x32_bf16 v[28:31], v[244:247], v[192:195], v[28:31]
    v_exp_f32 v183, v183
    v_mfma_f32_16x16x32_bf16 v[60:63], v[244:247], v[196:199], v[60:63]
    ds_read_b128 v[240:243], v249 offset:3072
    s_waitcnt lgkmcnt(2)
    v_mfma_f32_16x16x32_bf16 v[160:163], v[228:231], v[64:67], v[208:211]
    v_exp_f32 v188, v188
    v_mfma_f32_16x16x32_bf16 v[168:171], v[228:231], v[80:83], v[212:215]
    ds_read_b128 v[244:247], v249 offset:4096
    buffer_load_dwordx4 v[104:107], v252, s[4:7], s23 offen offset:128 nt
    v_mfma_f32_16x16x32_bf16 v[160:163], v[232:235], v[68:71], v[160:163]
    v_exp_f32 v189, v189
    v_mfma_f32_16x16x32_bf16 v[168:171], v[232:235], v[84:87], v[168:171]
    ds_read_b128 v[228:231], v249 offset:5120
    s_waitcnt lgkmcnt(2)
    v_mfma_f32_16x16x32_bf16 v[160:163], v[236:239], v[72:75], v[160:163]
    v_exp_f32 v190, v190
    v_mfma_f32_16x16x32_bf16 v[168:171], v[236:239], v[88:91], v[168:171]
    ds_read_b128 v[232:235], v249 offset:6144
    v_cvt_pk_bf16_f32 v202, v180, v181
    v_mfma_f32_16x16x32_bf16 v[160:163], v[240:243], v[76:79], v[160:163]
    v_exp_f32 v191, v191
    v_mfma_f32_16x16x32_bf16 v[168:171], v[240:243], v[92:95], v[168:171]
    ds_read_b128 v[236:239], v249 offset:7168
    s_waitcnt lgkmcnt(2)
    v_mfma_f32_16x16x32_bf16 v[164:167], v[244:247], v[64:67], v[208:211]
    v_cvt_pk_bf16_f32 v203, v182, v183
    v_cvt_pk_bf16_f32 v206, v188, v189
    v_mfma_f32_16x16x32_bf16 v[172:175], v[244:247], v[80:83], v[212:215]
    s_barrier
    ds_read_b128 v[240:243], v250 offset:57344
    v_cvt_pk_bf16_f32 v207, v190, v191
    v_mfma_f32_16x16x32_bf16 v[164:167], v[228:231], v[68:71], v[164:167]
    v_exp_f32 v160, v160
    v_mfma_f32_16x16x32_bf16 v[172:175], v[228:231], v[84:87], v[172:175]
    ds_read_b128 v[244:247], v250 offset:58368
    buffer_load_dwordx4 v[108:111], v252, s[4:7], s23 offen offset:192 nt
    s_waitcnt lgkmcnt(2)
    v_mfma_f32_16x16x32_bf16 v[164:167], v[232:235], v[72:75], v[164:167]
    v_exp_f32 v161, v161
    v_mfma_f32_16x16x32_bf16 v[172:175], v[232:235], v[88:91], v[172:175]
    ds_read_b128 v[228:231], v250 offset:59392
    v_cvt_pk_bf16_f32 v192, v160, v161
    v_mfma_f32_16x16x32_bf16 v[164:167], v[236:239], v[76:79], v[164:167]
    v_exp_f32 v162, v162
    v_mfma_f32_16x16x32_bf16 v[172:175], v[236:239], v[92:95], v[172:175]
    ds_read_b128 v[232:235], v250 offset:60416
    v_mfma_f32_16x16x32_bf16 v[216:219], v[224:227], v[200:203], v[216:219]
    v_exp_f32 v163, v163
    v_mfma_f32_16x16x32_bf16 v[220:223], v[224:227], v[204:207], v[220:223]
    s_waitcnt lgkmcnt(2)
    v_mfma_f32_16x16x32_bf16 v[0:3], v[240:243], v[200:203], v[0:3]
    v_exp_f32 v168, v168
    v_mfma_f32_16x16x32_bf16 v[32:35], v[240:243], v[204:207], v[32:35]
    ds_read_b128 v[236:239], v250 offset:61440
    v_cvt_pk_bf16_f32 v193, v162, v163
    v_mfma_f32_16x16x32_bf16 v[4:7], v[244:247], v[200:203], v[4:7]
    v_exp_f32 v169, v169
    v_mfma_f32_16x16x32_bf16 v[36:39], v[244:247], v[204:207], v[36:39]
    ds_read_b128 v[240:243], v250 offset:62464
    s_waitcnt lgkmcnt(2)
    v_mfma_f32_16x16x32_bf16 v[8:11], v[228:231], v[200:203], v[8:11]
    v_exp_f32 v170, v170
    v_mfma_f32_16x16x32_bf16 v[40:43], v[228:231], v[204:207], v[40:43]
    ds_read_b128 v[244:247], v250 offset:63488
    buffer_load_dwordx4 v[112:115], v252, s[4:7], s24 offen offset:0 nt
    v_mfma_f32_16x16x32_bf16 v[12:15], v[232:235], v[200:203], v[12:15]
    v_exp_f32 v171, v171
    v_mfma_f32_16x16x32_bf16 v[44:47], v[232:235], v[204:207], v[44:47]
    ds_read_b128 v[228:231], v250 offset:64512
    s_waitcnt lgkmcnt(2)
    v_mfma_f32_16x16x32_bf16 v[16:19], v[236:239], v[200:203], v[16:19]
    v_exp_f32 v164, v164
    v_mfma_f32_16x16x32_bf16 v[48:51], v[236:239], v[204:207], v[48:51]
    ds_read_b128 v[232:235], v249 offset:8192
    v_cvt_pk_bf16_f32 v196, v168, v169
    v_mfma_f32_16x16x32_bf16 v[20:23], v[240:243], v[200:203], v[20:23]
    v_exp_f32 v165, v165
    v_mfma_f32_16x16x32_bf16 v[52:55], v[240:243], v[204:207], v[52:55]
    ds_read_b128 v[236:239], v249 offset:9216
    s_waitcnt lgkmcnt(2)
    v_mfma_f32_16x16x32_bf16 v[24:27], v[244:247], v[200:203], v[24:27]
    v_exp_f32 v166, v166
    v_mfma_f32_16x16x32_bf16 v[56:59], v[244:247], v[204:207], v[56:59]
    ds_read_b128 v[240:243], v249 offset:10240
    v_cvt_pk_bf16_f32 v197, v170, v171
    v_mfma_f32_16x16x32_bf16 v[28:31], v[228:231], v[200:203], v[28:31]
    v_exp_f32 v167, v167
    v_mfma_f32_16x16x32_bf16 v[60:63], v[228:231], v[204:207], v[60:63]
    ds_read_b128 v[244:247], v249 offset:11264
    buffer_load_dwordx4 v[116:119], v252, s[4:7], s24 offen offset:64 nt
    s_waitcnt lgkmcnt(2)
    v_mfma_f32_16x16x32_bf16 v[176:179], v[232:235], v[64:67], v[208:211]
    v_exp_f32 v172, v172
    v_cvt_pk_bf16_f32 v194, v164, v165
    v_mfma_f32_16x16x32_bf16 v[184:187], v[232:235], v[80:83], v[212:215]
    ds_read_b128 v[228:231], v249 offset:12288
    v_cvt_pk_bf16_f32 v195, v166, v167
    v_mfma_f32_16x16x32_bf16 v[176:179], v[236:239], v[68:71], v[176:179]
    v_exp_f32 v173, v173
    v_mfma_f32_16x16x32_bf16 v[184:187], v[236:239], v[84:87], v[184:187]
    ds_read_b128 v[232:235], v249 offset:13312
    v_cvt_pk_bf16_f32 v198, v172, v173
    s_waitcnt lgkmcnt(2)
    v_mfma_f32_16x16x32_bf16 v[176:179], v[240:243], v[72:75], v[176:179]
    v_exp_f32 v174, v174
    v_mfma_f32_16x16x32_bf16 v[184:187], v[240:243], v[88:91], v[184:187]
    ds_read_b128 v[236:239], v249 offset:14336
    v_exp_f32 v175, v175
    v_mfma_f32_16x16x32_bf16 v[176:179], v[244:247], v[76:79], v[176:179]
    v_cvt_pk_bf16_f32 v199, v174, v175
    v_mfma_f32_16x16x32_bf16 v[184:187], v[244:247], v[92:95], v[184:187]
    ds_read_b128 v[240:243], v249 offset:15360
    s_waitcnt lgkmcnt(2)
    v_mfma_f32_16x16x32_bf16 v[180:183], v[228:231], v[64:67], v[208:211]
    v_mfma_f32_16x16x32_bf16 v[188:191], v[228:231], v[80:83], v[212:215]
    ds_read_b128 v[244:247], v251 offset:0
    buffer_load_dwordx4 v[120:123], v252, s[4:7], s24 offen offset:128 nt
    v_mfma_f32_16x16x32_bf16 v[180:183], v[232:235], v[68:71], v[180:183]
    v_exp_f32 v176, v176
    v_mfma_f32_16x16x32_bf16 v[188:191], v[232:235], v[84:87], v[188:191]
    ds_read_b128 v[228:231], v251 offset:1024
    s_waitcnt lgkmcnt(2)
    v_mfma_f32_16x16x32_bf16 v[180:183], v[236:239], v[72:75], v[180:183]
    v_exp_f32 v177, v177
    v_mfma_f32_16x16x32_bf16 v[188:191], v[236:239], v[88:91], v[188:191]
    ds_read_b128 v[232:235], v251 offset:2048
    v_cvt_pk_bf16_f32 v200, v176, v177
    v_mfma_f32_16x16x32_bf16 v[180:183], v[240:243], v[76:79], v[180:183]
    v_exp_f32 v178, v178
    v_mfma_f32_16x16x32_bf16 v[188:191], v[240:243], v[92:95], v[188:191]
    ds_read_b128 v[236:239], v251 offset:3072
    v_mfma_f32_16x16x32_bf16 v[216:219], v[224:227], v[192:195], v[216:219]
    v_exp_f32 v179, v179
    v_mfma_f32_16x16x32_bf16 v[220:223], v[224:227], v[196:199], v[220:223]
    s_waitcnt lgkmcnt(2)
    v_mfma_f32_16x16x32_bf16 v[0:3], v[244:247], v[192:195], v[0:3]
    v_exp_f32 v184, v184
    v_cvt_pk_bf16_f32 v201, v178, v179
    v_mfma_f32_16x16x32_bf16 v[32:35], v[244:247], v[196:199], v[32:35]
    ds_read_b128 v[240:243], v251 offset:4096
    v_exp_f32 v185, v185
    v_mfma_f32_16x16x32_bf16 v[4:7], v[228:231], v[192:195], v[4:7]
    v_exp_f32 v186, v186
    v_cvt_pk_bf16_f32 v204, v184, v185
    v_mfma_f32_16x16x32_bf16 v[36:39], v[228:231], v[196:199], v[36:39]
    ds_read_b128 v[244:247], v251 offset:5120
    buffer_load_dwordx4 v[124:127], v252, s[4:7], s24 offen offset:192 nt
    s_waitcnt lgkmcnt(2)
    v_mfma_f32_16x16x32_bf16 v[8:11], v[232:235], v[192:195], v[8:11]
    v_exp_f32 v187, v187
    v_mfma_f32_16x16x32_bf16 v[40:43], v[232:235], v[196:199], v[40:43]
    ds_read_b128 v[228:231], v251 offset:6144
    v_cvt_pk_bf16_f32 v205, v186, v187
    v_mfma_f32_16x16x32_bf16 v[12:15], v[236:239], v[192:195], v[12:15]
    v_exp_f32 v180, v180
    v_mfma_f32_16x16x32_bf16 v[44:47], v[236:239], v[196:199], v[44:47]
    ds_read_b128 v[232:235], v251 offset:7168
    s_waitcnt lgkmcnt(2)
    v_mfma_f32_16x16x32_bf16 v[16:19], v[240:243], v[192:195], v[16:19]
    v_exp_f32 v181, v181
    v_exp_f32 v182, v182
    v_mfma_f32_16x16x32_bf16 v[48:51], v[240:243], v[196:199], v[48:51]
    ds_read_b128 v[236:239], v251 offset:8192
    v_cvt_pk_bf16_f32 v202, v180, v181
    v_mfma_f32_16x16x32_bf16 v[20:23], v[244:247], v[192:195], v[20:23]
    v_exp_f32 v183, v183
    v_exp_f32 v188, v188
    v_mfma_f32_16x16x32_bf16 v[52:55], v[244:247], v[196:199], v[52:55]
    ds_read_b128 v[240:243], v251 offset:9216
    v_cvt_pk_bf16_f32 v203, v182, v183
    s_waitcnt lgkmcnt(2)
    v_mfma_f32_16x16x32_bf16 v[24:27], v[228:231], v[192:195], v[24:27]
    v_exp_f32 v189, v189
    v_mfma_f32_16x16x32_bf16 v[56:59], v[228:231], v[196:199], v[56:59]
    ds_read_b128 v[244:247], v251 offset:10240
    v_cvt_pk_bf16_f32 v206, v188, v189
    v_exp_f32 v190, v190
    v_mfma_f32_16x16x32_bf16 v[28:31], v[232:235], v[192:195], v[28:31]
    v_exp_f32 v191, v191
    v_mfma_f32_16x16x32_bf16 v[60:63], v[232:235], v[196:199], v[60:63]
    ds_read_b128 v[228:231], v251 offset:11264
    v_cvt_pk_bf16_f32 v207, v190, v191
    v_mfma_f32_16x16x32_bf16 v[216:219], v[224:227], v[200:203], v[216:219]
    s_nop 0
    v_mfma_f32_16x16x32_bf16 v[220:223], v[224:227], v[204:207], v[220:223]
    s_waitcnt lgkmcnt(2)
    v_mfma_f32_16x16x32_bf16 v[0:3], v[236:239], v[200:203], v[0:3]
    v_mfma_f32_16x16x32_bf16 v[32:35], v[236:239], v[204:207], v[32:35]
    ds_read_b128 v[232:235], v251 offset:12288
    v_mfma_f32_16x16x32_bf16 v[4:7], v[240:243], v[200:203], v[4:7]
    v_mfma_f32_16x16x32_bf16 v[36:39], v[240:243], v[204:207], v[36:39]
    ds_read_b128 v[236:239], v251 offset:13312
    s_waitcnt lgkmcnt(2)
    v_mfma_f32_16x16x32_bf16 v[8:11], v[244:247], v[200:203], v[8:11]
    v_mfma_f32_16x16x32_bf16 v[40:43], v[244:247], v[204:207], v[40:43]
    ds_read_b128 v[240:243], v251 offset:14336
    v_mfma_f32_16x16x32_bf16 v[12:15], v[228:231], v[200:203], v[12:15]
    v_mfma_f32_16x16x32_bf16 v[44:47], v[228:231], v[204:207], v[44:47]
    ds_read_b128 v[244:247], v251 offset:15360
    s_waitcnt lgkmcnt(2)
    v_mfma_f32_16x16x32_bf16 v[16:19], v[232:235], v[200:203], v[16:19]
    v_mfma_f32_16x16x32_bf16 v[48:51], v[232:235], v[204:207], v[48:51]
    v_mfma_f32_16x16x32_bf16 v[20:23], v[236:239], v[200:203], v[20:23]
    v_mfma_f32_16x16x32_bf16 v[52:55], v[236:239], v[204:207], v[52:55]
    s_waitcnt lgkmcnt(0)
    v_mfma_f32_16x16x32_bf16 v[24:27], v[240:243], v[200:203], v[24:27]
    v_mfma_f32_16x16x32_bf16 v[56:59], v[240:243], v[204:207], v[56:59]
    v_mfma_f32_16x16x32_bf16 v[28:31], v[244:247], v[200:203], v[28:31]
    v_mfma_f32_16x16x32_bf16 v[60:63], v[244:247], v[204:207], v[60:63]
    s_setprio 0
    v_cmp_gt_f32 vcc, s29, v216
    v_cmp_gt_f32 s[38:39], s29, v220
    s_nop 0
    s_and_b64 vcc, vcc, s[38:39]
    s_cmp_eq_u64 vcc, -1
    s_cbranch_scc0 L_fix0
L_ok0:
    v_rcp_f32 v253, v216
    v_rcp_f32 v254, v220
    v_mul_f32 v0, v0, v253
    v_mul_f32 v1, v1, v253
    v_mul_f32 v2, v2, v253
    v_mul_f32 v3, v3, v253
    v_mul_f32 v4, v4, v253
    v_mul_f32 v5, v5, v253
    v_mul_f32 v6, v6, v253
    v_mul_f32 v7, v7, v253
    v_cvt_pk_bf16_f32 v64, v0, v1
    v_cvt_pk_bf16_f32 v65, v2, v3
    v_cvt_pk_bf16_f32 v66, v4, v5
    v_cvt_pk_bf16_f32 v67, v6, v7
    v_mul_f32 v8, v8, v253
    v_mul_f32 v9, v9, v253
    v_mul_f32 v10, v10, v253
    v_mul_f32 v11, v11, v253
    v_mul_f32 v12, v12, v253
    v_mul_f32 v13, v13, v253
    v_mul_f32 v14, v14, v253
    v_mul_f32 v15, v15, v253
    v_cvt_pk_bf16_f32 v68, v8, v9
    v_cvt_pk_bf16_f32 v69, v10, v11
    v_cvt_pk_bf16_f32 v70, v12, v13
    v_cvt_pk_bf16_f32 v71, v14, v15
    v_mul_f32 v32, v32, v254
    v_mul_f32 v33, v33, v254
    v_mul_f32 v34, v34, v254
    v_mul_f32 v35, v35, v254
    v_mul_f32 v36, v36, v254
    v_mul_f32 v37, v37, v254
    v_mul_f32 v38, v38, v254
    v_mul_f32 v39, v39, v254
    v_cvt_pk_bf16_f32 v80, v32, v33
    v_cvt_pk_bf16_f32 v81, v34, v35
    v_cvt_pk_bf16_f32 v82, v36, v37
    v_cvt_pk_bf16_f32 v83, v38, v39
    v_mul_f32 v40, v40, v254
    v_mul_f32 v41, v41, v254
    v_mul_f32 v42, v42, v254
    v_mul_f32 v43, v43, v254
    v_mul_f32 v44, v44, v254
    v_mul_f32 v45, v45, v254
    v_mul_f32 v46, v46, v254
    v_mul_f32 v47, v47, v254
    v_cvt_pk_bf16_f32 v84, v40, v41
    v_cvt_pk_bf16_f32 v85, v42, v43
    v_cvt_pk_bf16_f32 v86, v44, v45
    v_cvt_pk_bf16_f32 v87, v46, v47
    v_mul_f32 v16, v16, v253
    v_mul_f32 v17, v17, v253
    v_mul_f32 v18, v18, v253
    v_mul_f32 v19, v19, v253
    v_mul_f32 v20, v20, v253
    v_mul_f32 v21, v21, v253
    v_mul_f32 v22, v22, v253
    v_mul_f32 v23, v23, v253
    v_cvt_pk_bf16_f32 v72, v16, v17
    v_cvt_pk_bf16_f32 v73, v18, v19
    v_cvt_pk_bf16_f32 v74, v20, v21
    v_cvt_pk_bf16_f32 v75, v22, v23
    v_mul_f32 v24, v24, v253
    v_mul_f32 v25, v25, v253
    v_mul_f32 v26, v26, v253
    v_mul_f32 v27, v27, v253
    v_mul_f32 v28, v28, v253
    v_mul_f32 v29, v29, v253
    v_mul_f32 v30, v30, v253
    v_mul_f32 v31, v31, v253
    v_cvt_pk_bf16_f32 v76, v24, v25
    v_cvt_pk_bf16_f32 v77, v26, v27
    v_cvt_pk_bf16_f32 v78, v28, v29
    v_cvt_pk_bf16_f32 v79, v30, v31
    v_mul_f32 v48, v48, v254
    v_mul_f32 v49, v49, v254
    v_mul_f32 v50, v50, v254
    v_mul_f32 v51, v51, v254
    v_mul_f32 v52, v52, v254
    v_mul_f32 v53, v53, v254
    v_mul_f32 v54, v54, v254
    v_mul_f32 v55, v55, v254
    v_cvt_pk_bf16_f32 v88, v48, v49
    v_cvt_pk_bf16_f32 v89, v50, v51
    v_cvt_pk_bf16_f32 v90, v52, v53
    v_cvt_pk_bf16_f32 v91, v54, v55
    v_mul_f32 v56, v56, v254
    v_mul_f32 v57, v57, v254
    v_mul_f32 v58, v58, v254
    v_mul_f32 v59, v59, v254
    v_mul_f32 v60, v60, v254
    v_mul_f32 v61, v61, v254
    v_mul_f32 v62, v62, v254
    v_mul_f32 v63, v63, v254
    v_cvt_pk_bf16_f32 v92, v56, v57
    v_cvt_pk_bf16_f32 v93, v58, v59
    v_cvt_pk_bf16_f32 v94, v60, v61
    v_cvt_pk_bf16_f32 v95, v62, v63
    s_waitcnt vmcnt(0)
    ds_read_b128 v[228:231], v248 offset:0
    ds_read_b128 v[232:235], v248 offset:1024
    ds_read_b128 v[236:239], v248 offset:2048
    ds_read_b128 v[240:243], v248 offset:3072
    s_setprio 3
    s_waitcnt lgkmcnt(2)
    v_mfma_f32_16x16x32_bf16 v[160:163], v[228:231], v[96:99], 0
    v_mfma_f32_16x16x32_bf16 v[168:171], v[228:231], v[112:115], 0
    ds_read_b128 v[244:247], v248 offset:4096
    v_mfma_f32_16x16x32_bf16 v[160:163], v[232:235], v[100:103], v[160:163]
    v_mfma_f32_16x16x32_bf16 v[168:171], v[232:235], v[116:119], v[168:171]
    ds_read_b128 v[228:231], v248 offset:5120
    s_waitcnt lgkmcnt(2)
    v_mfma_f32_16x16x32_bf16 v[160:163], v[236:239], v[104:107], v[160:163]
    v_mfma_f32_16x16x32_bf16 v[168:171], v[236:239], v[120:123], v[168:171]
    ds_read_b128 v[232:235], v248 offset:6144
    v_mfma_f32_16x16x32_bf16 v[160:163], v[240:243], v[108:111], v[160:163]
    v_mfma_f32_16x16x32_bf16 v[168:171], v[240:243], v[124:127], v[168:171]
    ds_read_b128 v[236:239], v248 offset:7168
    s_waitcnt lgkmcnt(2)
    v_mfma_f32_16x16x32_bf16 v[164:167], v[244:247], v[96:99], 0
    v_mfma_f32_16x16x32_bf16 v[172:175], v[244:247], v[112:115], 0
    ds_read_b128 v[240:243], v248 offset:8192
    v_mfma_f32_16x16x32_bf16 v[164:167], v[228:231], v[100:103], v[164:167]
    v_mfma_f32_16x16x32_bf16 v[172:175], v[228:231], v[116:119], v[172:175]
    ds_read_b128 v[244:247], v248 offset:9216
    s_waitcnt lgkmcnt(2)
    v_mfma_f32_16x16x32_bf16 v[164:167], v[232:235], v[104:107], v[164:167]
    v_mfma_f32_16x16x32_bf16 v[172:175], v[232:235], v[120:123], v[172:175]
    ds_read_b128 v[228:231], v248 offset:10240
    v_mfma_f32_16x16x32_bf16 v[164:167], v[236:239], v[108:111], v[164:167]
    v_mfma_f32_16x16x32_bf16 v[172:175], v[236:239], v[124:127], v[172:175]
    ds_read_b128 v[232:235], v248 offset:11264
    s_waitcnt lgkmcnt(2)
    v_mfma_f32_16x16x32_bf16 v[176:179], v[240:243], v[96:99], 0
    v_mfma_f32_16x16x32_bf16 v[184:187], v[240:243], v[112:115], 0
    ds_read_b128 v[236:239], v248 offset:12288
    v_mfma_f32_16x16x32_bf16 v[176:179], v[244:247], v[100:103], v[176:179]
    v_mfma_f32_16x16x32_bf16 v[184:187], v[244:247], v[116:119], v[184:187]
    ds_read_b128 v[240:243], v248 offset:13312
    s_waitcnt lgkmcnt(2)
    v_mfma_f32_16x16x32_bf16 v[176:179], v[228:231], v[104:107], v[176:179]
    v_mfma_f32_16x16x32_bf16 v[184:187], v[228:231], v[120:123], v[184:187]
    ds_read_b128 v[244:247], v248 offset:14336
    v_mfma_f32_16x16x32_bf16 v[176:179], v[232:235], v[108:111], v[176:179]
    v_mfma_f32_16x16x32_bf16 v[184:187], v[232:235], v[124:127], v[184:187]
    ds_read_b128 v[228:231], v248 offset:15360
    s_waitcnt lgkmcnt(2)
    v_mfma_f32_16x16x32_bf16 v[180:183], v[236:239], v[96:99], 0
    v_mfma_f32_16x16x32_bf16 v[188:191], v[236:239], v[112:115], 0
    ds_read_b128 v[232:235], v250 offset:0
    v_mfma_f32_16x16x32_bf16 v[180:183], v[240:243], v[100:103], v[180:183]
    v_mfma_f32_16x16x32_bf16 v[188:191], v[240:243], v[116:119], v[188:191]
    ds_read_b128 v[236:239], v250 offset:1024
    s_waitcnt lgkmcnt(2)
    v_mfma_f32_16x16x32_bf16 v[180:183], v[244:247], v[104:107], v[180:183]
    v_mfma_f32_16x16x32_bf16 v[188:191], v[244:247], v[120:123], v[188:191]
    ds_read_b128 v[240:243], v250 offset:2048
    v_mfma_f32_16x16x32_bf16 v[180:183], v[228:231], v[108:111], v[180:183]
    v_mfma_f32_16x16x32_bf16 v[188:191], v[228:231], v[124:127], v[188:191]
    ds_read_b128 v[244:247], v250 offset:3072
    s_setprio 0
    s_cmp_ge_u32 s20, 4
    s_cbranch_scc1 L_noq2
    buffer_load_dwordx4 v[128:131], v252, s[4:7], s25 offen offset:0 nt
    buffer_load_dwordx4 v[132:135], v252, s[4:7], s25 offen offset:64 nt
    buffer_load_dwordx4 v[136:139], v252, s[4:7], s25 offen offset:128 nt
    buffer_load_dwordx4 v[140:143], v252, s[4:7], s25 offen offset:192 nt
    buffer_load_dwordx4 v[144:147], v252, s[4:7], s26 offen offset:0 nt
    buffer_load_dwordx4 v[148:151], v252, s[4:7], s26 offen offset:64 nt
    buffer_load_dwordx4 v[152:155], v252, s[4:7], s26 offen offset:128 nt
    buffer_load_dwordx4 v[156:159], v252, s[4:7], s26 offen offset:192 nt
L_noq2:
    v_max3_f32 v208, v160, v161, v162
    v_max3_f32 v212, v168, v169, v170
    v_max3_f32 v208, v163, v164, v208
    v_max3_f32 v212, v171, v172, v212
    v_max3_f32 v208, v165, v166, v208
    v_max3_f32 v212, v173, v174, v212
    v_max_f32 v208, v167, v208
    v_max_f32 v212, v175, v212
    s_nop 1
    v_permlane16_swap_b32 v208, v212
    v_max_f32 v208, v208, v212
    v_mov_b32 v212, v208
    s_nop 1
    v_permlane32_swap_b32 v208, v212
    v_max_f32 v208, v208, v212
    v_mov_b32 v212, v208
    s_nop 1
    v_permlane16_swap_b32 v208, v212
    v_sub_f32 v209, 0, v208
    v_sub_f32 v210, 0, v208
    v_sub_f32 v211, 0, v208
    v_sub_f32 v208, 0, v208
    v_sub_f32 v213, 0, v212
    v_sub_f32 v214, 0, v212
    v_sub_f32 v215, 0, v212
    v_sub_f32 v212, 0, v212
    v_add_f32 v160, v160, v208
    v_add_f32 v161, v161, v208
    v_exp_f32 v160, v160
    v_exp_f32 v161, v161
    v_add_f32 v162, v162, v208
    v_cvt_pk_bf16_f32 v192, v160, v161
    v_exp_f32 v162, v162
    v_add_f32 v163, v163, v208
    v_add_f32 v168, v168, v212
    v_exp_f32 v163, v163
    v_exp_f32 v168, v168
    v_cvt_pk_bf16_f32 v193, v162, v163
    v_add_f32 v169, v169, v212
    v_add_f32 v170, v170, v212
    v_exp_f32 v169, v169
    v_exp_f32 v170, v170
    v_cvt_pk_bf16_f32 v196, v168, v169
    v_add_f32 v171, v171, v212
    v_add_f32 v164, v164, v208
    v_exp_f32 v171, v171
    v_exp_f32 v164, v164
    v_cvt_pk_bf16_f32 v197, v170, v171
    v_add_f32 v165, v165, v208
    v_add_f32 v166, v166, v208
    v_exp_f32 v165, v165
    v_exp_f32 v166, v166
    v_cvt_pk_bf16_f32 v194, v164, v165
    v_add_f32 v167, v167, v208
    v_add_f32 v172, v172, v212
    v_exp_f32 v167, v167
    v_exp_f32 v172, v172
    v_cvt_pk_bf16_f32 v195, v166, v167
    v_add_f32 v173, v173, v212
    v_add_f32 v174, v174, v212
    v_exp_f32 v173, v173
    v_exp_f32 v174, v174
    v_cvt_pk_bf16_f32 v198, v172, v173
    v_add_f32 v175, v175, v212
    v_add_f32 v176, v176, v208
    v_exp_f32 v175, v175
    v_exp_f32 v176, v176
    v_cvt_pk_bf16_f32 v199, v174, v175
    v_add_f32 v177, v177, v208
    v_add_f32 v178, v178, v208
    v_exp_f32 v177, v177
    v_exp_f32 v178, v178
    v_cvt_pk_bf16_f32 v200, v176, v177
    v_add_f32 v179, v179, v208
    v_add_f32 v184, v184, v212
    v_exp_f32 v179, v179
    v_exp_f32 v184, v184
    v_cvt_pk_bf16_f32 v201, v178, v179
    v_add_f32 v185, v185, v212
    v_add_f32 v186, v186, v212
    v_exp_f32 v185, v185
    v_exp_f32 v186, v186
    v_cvt_pk_bf16_f32 v204, v184, v185
    v_add_f32 v187, v187, v212
    v_add_f32 v180, v180, v208
    v_exp_f32 v187, v187
    v_exp_f32 v180, v180
    v_cvt_pk_bf16_f32 v205, v186, v187
    v_add_f32 v181, v181, v208
    v_add_f32 v182, v182, v208
    v_exp_f32 v181, v181
    v_exp_f32 v182, v182
    v_cvt_pk_bf16_f32 v202, v180, v181
    v_add_f32 v183, v183, v208
    v_add_f32 v188, v188, v212
    v_exp_f32 v183, v183
    v_exp_f32 v188, v188
    v_cvt_pk_bf16_f32 v203, v182, v183
    v_add_f32 v189, v189, v212
    v_add_f32 v190, v190, v212
    v_exp_f32 v189, v189
    v_exp_f32 v190, v190
    v_cvt_pk_bf16_f32 v206, v188, v189
    v_add_f32 v191, v191, v212
    v_exp_f32 v191, v191
    s_nop 0
    v_cvt_pk_bf16_f32 v207, v190, v191
    s_setprio 1
    v_mfma_f32_16x16x32_bf16 v[216:219], v[224:227], v[192:195], 0
    v_mfma_f32_16x16x32_bf16 v[220:223], v[224:227], v[196:199], 0
    s_waitcnt lgkmcnt(2)
    v_mfma_f32_16x16x32_bf16 v[0:3], v[232:235], v[192:195], 0
    v_mfma_f32_16x16x32_bf16 v[32:35], v[232:235], v[196:199], 0
    ds_read_b128 v[228:231], v250 offset:4096
    v_mfma_f32_16x16x32_bf16 v[4:7], v[236:239], v[192:195], 0
    v_mfma_f32_16x16x32_bf16 v[36:39], v[236:239], v[196:199], 0
    ds_read_b128 v[232:235], v250 offset:5120
    s_waitcnt lgkmcnt(2)
    v_mfma_f32_16x16x32_bf16 v[8:11], v[240:243], v[192:195], 0
    v_mfma_f32_16x16x32_bf16 v[40:43], v[240:243], v[196:199], 0
    ds_read_b128 v[236:239], v250 offset:6144
    v_mfma_f32_16x16x32_bf16 v[12:15], v[244:247], v[192:195], 0
    v_mfma_f32_16x16x32_bf16 v[44:47], v[244:247], v[196:199], 0
    ds_read_b128 v[240:243], v250 offset:7168
    s_waitcnt lgkmcnt(2)
    v_mfma_f32_16x16x32_bf16 v[16:19], v[228:231], v[192:195], 0
    v_mfma_f32_16x16x32_bf16 v[48:51], v[228:231], v[196:199], 0
    ds_read_b128 v[244:247], v248 offset:16384
    v_mfma_f32_16x16x32_bf16 v[20:23], v[232:235], v[192:195], 0
    v_mfma_f32_16x16x32_bf16 v[52:55], v[232:235], v[196:199], 0
    ds_read_b128 v[228:231], v248 offset:17408
    s_waitcnt lgkmcnt(2)
    v_mfma_f32_16x16x32_bf16 v[24:27], v[236:239], v[192:195], 0
    v_mfma_f32_16x16x32_bf16 v[56:59], v[236:239], v[196:199], 0
    ds_read_b128 v[232:235], v248 offset:18432
    v_mfma_f32_16x16x32_bf16 v[28:31], v[240:243], v[192:195], 0
    v_mfma_f32_16x16x32_bf16 v[60:63], v[240:243], v[196:199], 0
    ds_read_b128 v[236:239], v248 offset:19456
    s_waitcnt lgkmcnt(2)
    v_mfma_f32_16x16x32_bf16 v[160:163], v[244:247], v[96:99], v[208:211]
    v_mfma_f32_16x16x32_bf16 v[168:171], v[244:247], v[112:115], v[212:215]
    ds_read_b128 v[240:243], v248 offset:20480
    v_mfma_f32_16x16x32_bf16 v[160:163], v[228:231], v[100:103], v[160:163]
    v_mfma_f32_16x16x32_bf16 v[168:171], v[228:231], v[116:119], v[168:171]
    ds_read_b128 v[244:247], v248 offset:21504
    s_waitcnt lgkmcnt(2)
    v_mfma_f32_16x16x32_bf16 v[160:163], v[232:235], v[104:107], v[160:163]
    v_mfma_f32_16x16x32_bf16 v[168:171], v[232:235], v[120:123], v[168:171]
    ds_read_b128 v[228:231], v248 offset:22528
    v_mfma_f32_16x16x32_bf16 v[160:163], v[236:239], v[108:111], v[160:163]
    v_mfma_f32_16x16x32_bf16 v[168:171], v[236:239], v[124:127], v[168:171]
    ds_read_b128 v[232:235], v248 offset:23552
    s_waitcnt lgkmcnt(2)
    v_mfma_f32_16x16x32_bf16 v[164:167], v[240:243], v[96:99], v[208:211]
    v_mfma_f32_16x16x32_bf16 v[172:175], v[240:243], v[112:115], v[212:215]
    ds_read_b128 v[236:239], v250 offset:8192
    v_mfma_f32_16x16x32_bf16 v[164:167], v[244:247], v[100:103], v[164:167]
    s_nop 0
    v_exp_f32 v160, v160
    v_mfma_f32_16x16x32_bf16 v[172:175], v[244:247], v[116:119], v[172:175]
    ds_read_b128 v[240:243], v250 offset:9216
    s_waitcnt lgkmcnt(2)
    v_mfma_f32_16x16x32_bf16 v[164:167], v[228:231], v[104:107], v[164:167]
    v_exp_f32 v161, v161
    v_mfma_f32_16x16x32_bf16 v[172:175], v[228:231], v[120:123], v[172:175]
    ds_read_b128 v[244:247], v250 offset:10240
    v_cvt_pk_bf16_f32 v192, v160, v161
    v_mfma_f32_16x16x32_bf16 v[164:167], v[232:235], v[108:111], v[164:167]
    v_exp_f32 v162, v162
    v_mfma_f32_16x16x32_bf16 v[172:175], v[232:235], v[124:127], v[172:175]
    ds_read_b128 v[228:231], v250 offset:11264
    v_mfma_f32_16x16x32_bf16 v[216:219], v[224:227], v[200:203], v[216:219]
    v_exp_f32 v163, v163
    v_mfma_f32_16x16x32_bf16 v[220:223], v[224:227], v[204:207], v[220:223]
    s_waitcnt lgkmcnt(2)
    v_mfma_f32_16x16x32_bf16 v[0:3], v[236:239], v[200:203], v[0:3]
    v_exp_f32 v168, v168
    v_mfma_f32_16x16x32_bf16 v[32:35], v[236:239], v[204:207], v[32:35]
    ds_read_b128 v[232:235], v250 offset:12288
    v_cvt_pk_bf16_f32 v193, v162, v163
    v_mfma_f32_16x16x32_bf16 v[4:7], v[240:243], v[200:203], v[4:7]
    v_exp_f32 v169, v169
    v_mfma_f32_16x16x32_bf16 v[36:39], v[240:243], v[204:207], v[36:39]
    ds_read_b128 v[236:239], v250 offset:13312
    s_waitcnt lgkmcnt(2)
    v_mfma_f32_16x16x32_bf16 v[8:11], v[244:247], v[200:203], v[8:11]
    v_exp_f32 v170, v170
    v_mfma_f32_16x16x32_bf16 v[40:43], v[244:247], v[204:207], v[40:43]
    ds_read_b128 v[240:243], v250 offset:14336
    v_cvt_pk_bf16_f32 v196, v168, v169
    v_mfma_f32_16x16x32_bf16 v[12:15], v[228:231], v[200:203], v[12:15]
    v_exp_f32 v171, v171
    v_mfma_f32_16x16x32_bf16 v[44:47], v[228:231], v[204:207], v[44:47]
    ds_read_b128 v[244:247], v250 offset:15360
    s_waitcnt lgkmcnt(2)
    v_mfma_f32_16x16x32_bf16 v[16:19], v[232:235], v[200:203], v[16:19]
    v_exp_f32 v164, v164
    v_mfma_f32_16x16x32_bf16 v[48:51], v[232:235], v[204:207], v[48:51]
    ds_read_b128 v[228:231], v248 offset:24576
    v_cvt_pk_bf16_f32 v197, v170, v171
    v_mfma_f32_16x16x32_bf16 v[20:23], v[236:239], v[200:203], v[20:23]
    v_exp_f32 v165, v165
    v_mfma_f32_16x16x32_bf16 v[52:55], v[236:239], v[204:207], v[52:55]
    ds_read_b128 v[232:235], v248 offset:25600
    s_waitcnt lgkmcnt(2)
    v_mfma_f32_16x16x32_bf16 v[24:27], v[240:243], v[200:203], v[24:27]
    v_exp_f32 v166, v166
    v_mfma_f32_16x16x32_bf16 v[56:59], v[240:243], v[204:207], v[56:59]
    ds_read_b128 v[236:239], v248 offset:26624
    v_cvt_pk_bf16_f32 v194, v164, v165
    v_mfma_f32_16x16x32_bf16 v[28:31], v[244:247], v[200:203], v[28:31]
    v_exp_f32 v167, v167
    v_mfma_f32_16x16x32_bf16 v[60:63], v[244:247], v[204:207], v[60:63]
    ds_read_b128 v[240:243], v248 offset:27648
    s_waitcnt lgkmcnt(2)
    v_mfma_f32_16x16x32_bf16 v[176:179], v[228:231], v[96:99], v[208:211]
    v_exp_f32 v172, v172
    v_mfma_f32_16x16x32_bf16 v[184:187], v[228:231], v[112:115], v[212:215]
    ds_read_b128 v[244:247], v248 offset:28672
    v_cvt_pk_bf16_f32 v195, v166, v167
    v_mfma_f32_16x16x32_bf16 v[176:179], v[232:235], v[100:103], v[176:179]
    v_exp_f32 v173, v173
    v_mfma_f32_16x16x32_bf16 v[184:187], v[232:235], v[116:119], v[184:187]
    ds_read_b128 v[228:231], v248 offset:29696
    s_waitcnt lgkmcnt(2)
    v_mfma_f32_16x16x32_bf16 v[176:179], v[236:239], v[104:107], v[176:179]
    v_exp_f32 v174, v174
    v_mfma_f32_16x16x32_bf16 v[184:187], v[236:239], v[120:123], v[184:187]
    ds_read_b128 v[232:235], v248 offset:30720
    v_cvt_pk_bf16_f32 v198, v172, v173
    v_mfma_f32_16x16x32_bf16 v[176:179], v[240:243], v[108:111], v[176:179]
    v_exp_f32 v175, v175
    v_mfma_f32_16x16x32_bf16 v[184:187], v[240:243], v[124:127], v[184:187]
    ds_read_b128 v[236:239], v248 offset:31744
    s_waitcnt lgkmcnt(2)
    v_mfma_f32_16x16x32_bf16 v[180:183], v[244:247], v[96:99], v[208:211]
    v_cvt_pk_bf16_f32 v199, v174, v175
    v_mfma_f32_16x16x32_bf16 v[188:191], v[244:247], v[112:115], v[212:215]
    ds_read_b128 v[240:243], v250 offset:16384
    v_mfma_f32_16x16x32_bf16 v[180:183], v[228:231], v[100:103], v[180:183]
    v_exp_f32 v176, v176
    v_mfma_f32_16x16x32_bf16 v[188:191], v[228:231], v[116:119], v[188:191]
    ds_read_b128 v[244:247], v250 offset:17408
    s_waitcnt lgkmcnt(2)
    v_mfma_f32_16x16x32_bf16 v[180:183], v[232:235], v[104:107], v[180:183]
    v_exp_f32 v177, v177
    v_mfma_f32_16x16x32_bf16 v[188:191], v[232:235], v[120:123], v[188:191]
    ds_read_b128 v[228:231], v250 offset:18432
    v_cvt_pk_bf16_f32 v200, v176, v177
    v_mfma_f32_16x16x32_bf16 v[180:183], v[236:239], v[108:111], v[180:183]
    v_exp_f32 v178, v178
    v_mfma_f32_16x16x32_bf16 v[188:191], v[236:239], v[124:127], v[188:191]
    ds_read_b128 v[232:235], v250 offset:19456
    v_mfma_f32_16x16x32_bf16 v[216:219], v[224:227], v[192:195], v[216:219]
    v_exp_f32 v179, v179
    v_mfma_f32_16x16x32_bf16 v[220:223], v[224:227], v[196:199], v[220:223]
    s_waitcnt lgkmcnt(2)
    v_mfma_f32_16x16x32_bf16 v[0:3], v[240:243], v[192:195], v[0:3]
    v_exp_f32 v184, v184
    v_mfma_f32_16x16x32_bf16 v[32:35], v[240:243], v[196:199], v[32:35]
    ds_read_b128 v[236:239], v250 offset:20480
    v_cvt_pk_bf16_f32 v201, v178, v179
    v_mfma_f32_16x16x32_bf16 v[4:7], v[244:247], v[192:195], v[4:7]
    v_exp_f32 v185, v185
    v_mfma_f32_16x16x32_bf16 v[36:39], v[244:247], v[196:199], v[36:39]
    ds_read_b128 v[240:243], v250 offset:21504
    s_waitcnt lgkmcnt(2)
    v_mfma_f32_16x16x32_bf16 v[8:11], v[228:231], v[192:195], v[8:11]
    v_exp_f32 v186, v186
    v_mfma_f32_16x16x32_bf16 v[40:43], v[228:231], v[196:199], v[40:43]
    ds_read_b128 v[244:247], v250 offset:22528
    v_cvt_pk_bf16_f32 v204, v184, v185
    v_mfma_f32_16x16x32_bf16 v[12:15], v[232:235], v[192:195], v[12:15]
    v_exp_f32 v187, v187
    v_mfma_f32_16x16x32_bf16 v[44:47], v[232:235], v[196:199], v[44:47]
    ds_read_b128 v[228:231], v250 offset:23552
    s_waitcnt lgkmcnt(2)
    v_mfma_f32_16x16x32_bf16 v[16:19], v[236:239], v[192:195], v[16:19]
    v_exp_f32 v180, v180
    v_mfma_f32_16x16x32_bf16 v[48:51], v[236:239], v[196:199], v[48:51]
    ds_read_b128 v[232:235], v248 offset:32768
    v_cvt_pk_bf16_f32 v205, v186, v187
    v_mfma_f32_16x16x32_bf16 v[20:23], v[240:243], v[192:195], v[20:23]
    v_exp_f32 v181, v181
    v_mfma_f32_16x16x32_bf16 v[52:55], v[240:243], v[196:199], v[52:55]
    ds_read_b128 v[236:239], v248 offset:33792
    s_waitcnt lgkmcnt(2)
    v_mfma_f32_16x16x32_bf16 v[24:27], v[244:247], v[192:195], v[24:27]
    v_exp_f32 v182, v182
    v_mfma_f32_16x16x32_bf16 v[56:59], v[244:247], v[196:199], v[56:59]
    ds_read_b128 v[240:243], v248 offset:34816
    v_cvt_pk_bf16_f32 v202, v180, v181
    v_mfma_f32_16x16x32_bf16 v[28:31], v[228:231], v[192:195], v[28:31]
    v_exp_f32 v183, v183
    v_mfma_f32_16x16x32_bf16 v[60:63], v[228:231], v[196:199], v[60:63]
    ds_read_b128 v[244:247], v248 offset:35840
    s_waitcnt lgkmcnt(2)
    v_mfma_f32_16x16x32_bf16 v[160:163], v[232:235], v[96:99], v[208:211]
    v_exp_f32 v188, v188
    v_mfma_f32_16x16x32_bf16 v[168:171], v[232:235], v[112:115], v[212:215]
    ds_read_b128 v[228:231], v248 offset:36864
    v_cvt_pk_bf16_f32 v203, v182, v183
    v_mfma_f32_16x16x32_bf16 v[160:163], v[236:239], v[100:103], v[160:163]
    v_exp_f32 v189, v189
    v_mfma_f32_16x16x32_bf16 v[168:171], v[236:239], v[116:119], v[168:171]
    ds_read_b128 v[232:235], v248 offset:37888
    s_waitcnt lgkmcnt(2)
    v_mfma_f32_16x16x32_bf16 v[160:163], v[240:243], v[104:107], v[160:163]
    v_exp_f32 v190, v190
    v_mfma_f32_16x16x32_bf16 v[168:171], v[240:243], v[120:123], v[168:171]
    ds_read_b128 v[236:239], v248 offset:38912
    v_cvt_pk_bf16_f32 v206, v188, v189
    v_mfma_f32_16x16x32_bf16 v[160:163], v[244:247], v[108:111], v[160:163]
    v_exp_f32 v191, v191
    v_mfma_f32_16x16x32_bf16 v[168:171], v[244:247], v[124:127], v[168:171]
    ds_read_b128 v[240:243], v248 offset:39936
    s_waitcnt lgkmcnt(2)
    v_mfma_f32_16x16x32_bf16 v[164:167], v[228:231], v[96:99], v[208:211]
    v_cvt_pk_bf16_f32 v207, v190, v191
    v_mfma_f32_16x16x32_bf16 v[172:175], v[228:231], v[112:115], v[212:215]
    ds_read_b128 v[244:247], v250 offset:24576
    v_mfma_f32_16x16x32_bf16 v[164:167], v[232:235], v[100:103], v[164:167]
    v_exp_f32 v160, v160
    v_mfma_f32_16x16x32_bf16 v[172:175], v[232:235], v[116:119], v[172:175]
    ds_read_b128 v[228:231], v250 offset:25600
    s_waitcnt lgkmcnt(2)
    v_mfma_f32_16x16x32_bf16 v[164:167], v[236:239], v[104:107], v[164:167]
    v_exp_f32 v161, v161
    v_mfma_f32_16x16x32_bf16 v[172:175], v[236:239], v[120:123], v[172:175]
    ds_read_b128 v[232:235], v250 offset:26624
    v_cvt_pk_bf16_f32 v192, v160, v161
    v_mfma_f32_16x16x32_bf16 v[164:167], v[240:243], v[108:111], v[164:167]
    v_exp_f32 v162, v162
    v_mfma_f32_16x16x32_bf16 v[172:175], v[240:243], v[124:127], v[172:175]
    ds_read_b128 v[236:239], v250 offset:27648
    v_mfma_f32_16x16x32_bf16 v[216:219], v[224:227], v[200:203], v[216:219]
    v_exp_f32 v163, v163
    v_mfma_f32_16x16x32_bf16 v[220:223], v[224:227], v[204:207], v[220:223]
    s_waitcnt lgkmcnt(2)
    v_mfma_f32_16x16x32_bf16 v[0:3], v[244:247], v[200:203], v[0:3]
    v_exp_f32 v168, v168
    v_mfma_f32_16x16x32_bf16 v[32:35], v[244:247], v[204:207], v[32:35]
    ds_read_b128 v[240:243], v250 offset:28672
    v_cvt_pk_bf16_f32 v193, v162, v163
    v_mfma_f32_16x16x32_bf16 v[4:7], v[228:231], v[200:203], v[4:7]
    v_exp_f32 v169, v169
    v_mfma_f32_16x16x32_bf16 v[36:39], v[228:231], v[204:207], v[36:39]
    ds_read_b128 v[244:247], v250 offset:29696
    buffer_store_dwordx4 v[64:67], v252, s[16:19], s21 offen offset:0 sc1
    buffer_store_dwordx4 v[68:71], v252, s[16:19], s21 offen offset:64 sc1
    s_waitcnt lgkmcnt(2)
    v_mfma_f32_16x16x32_bf16 v[8:11], v[232:235], v[200:203], v[8:11]
    v_exp_f32 v170, v170
    v_mfma_f32_16x16x32_bf16 v[40:43], v[232:235], v[204:207], v[40:43]
    ds_read_b128 v[228:231], v250 offset:30720
    v_cvt_pk_bf16_f32 v196, v168, v169
    v_mfma_f32_16x16x32_bf16 v[12:15], v[236:239], v[200:203], v[12:15]
    v_exp_f32 v171, v171
    v_mfma_f32_16x16x32_bf16 v[44:47], v[236:239], v[204:207], v[44:47]
    ds_read_b128 v[232:235], v250 offset:31744
    s_waitcnt lgkmcnt(2)
    v_mfma_f32_16x16x32_bf16 v[16:19], v[240:243], v[200:203], v[16:19]
    v_exp_f32 v164, v164
    v_mfma_f32_16x16x32_bf16 v[48:51], v[240:243], v[204:207], v[48:51]
    ds_read_b128 v[236:239], v248 offset:40960
    v_cvt_pk_bf16_f32 v197, v170, v171
    v_mfma_f32_16x16x32_bf16 v[20:23], v[244:247], v[200:203], v[20:23]
    v_exp_f32 v165, v165
    v_mfma_f32_16x16x32_bf16 v[52:55], v[244:247], v[204:207], v[52:55]
    ds_read_b128 v[240:243], v248 offset:41984
    s_waitcnt lgkmcnt(2)
    v_mfma_f32_16x16x32_bf16 v[24:27], v[228:231], v[200:203], v[24:27]
    v_exp_f32 v166, v166
    v_mfma_f32_16x16x32_bf16 v[56:59], v[228:231], v[204:207], v[56:59]
    ds_read_b128 v[244:247], v248 offset:43008
    v_cvt_pk_bf16_f32 v194, v164, v165
    v_mfma_f32_16x16x32_bf16 v[28:31], v[232:235], v[200:203], v[28:31]
    v_exp_f32 v167, v167
    v_mfma_f32_16x16x32_bf16 v[60:63], v[232:235], v[204:207], v[60:63]
    ds_read_b128 v[228:231], v248 offset:44032
    s_waitcnt lgkmcnt(2)
    v_mfma_f32_16x16x32_bf16 v[176:179], v[236:239], v[96:99], v[208:211]
    v_exp_f32 v172, v172
    v_mfma_f32_16x16x32_bf16 v[184:187], v[236:239], v[112:115], v[212:215]
    ds_read_b128 v[232:235], v248 offset:45056
    v_cvt_pk_bf16_f32 v195, v166, v167
    v_mfma_f32_16x16x32_bf16 v[176:179], v[240:243], v[100:103], v[176:179]
    v_exp_f32 v173, v173
    v_mfma_f32_16x16x32_bf16 v[184:187], v[240:243], v[116:119], v[184:187]
    ds_read_b128 v[236:239], v248 offset:46080
    s_waitcnt lgkmcnt(2)
    v_mfma_f32_16x16x32_bf16 v[176:179], v[244:247], v[104:107], v[176:179]
    v_exp_f32 v174, v174
    v_mfma_f32_16x16x32_bf16 v[184:187], v[244:247], v[120:123], v[184:187]
    ds_read_b128 v[240:243], v248 offset:47104
    v_cvt_pk_bf16_f32 v198, v172, v173
    v_mfma_f32_16x16x32_bf16 v[176:179], v[228:231], v[108:111], v[176:179]
    v_exp_f32 v175, v175
    v_mfma_f32_16x16x32_bf16 v[184:187], v[228:231], v[124:127], v[184:187]
    ds_read_b128 v[244:247], v248 offset:48128
    s_waitcnt lgkmcnt(2)
    v_mfma_f32_16x16x32_bf16 v[180:183], v[232:235], v[96:99], v[208:211]
    v_cvt_pk_bf16_f32 v199, v174, v175
    v_mfma_f32_16x16x32_bf16 v[188:191], v[232:235], v[112:115], v[212:215]
    ds_read_b128 v[228:231], v250 offset:32768
    v_mfma_f32_16x16x32_bf16 v[180:183], v[236:239], v[100:103], v[180:183]
    v_exp_f32 v176, v176
    v_mfma_f32_16x16x32_bf16 v[188:191], v[236:239], v[116:119], v[188:191]
    ds_read_b128 v[232:235], v250 offset:33792
    s_waitcnt lgkmcnt(2)
    v_mfma_f32_16x16x32_bf16 v[180:183], v[240:243], v[104:107], v[180:183]
    v_exp_f32 v177, v177
    v_mfma_f32_16x16x32_bf16 v[188:191], v[240:243], v[120:123], v[188:191]
    ds_read_b128 v[236:239], v250 offset:34816
    v_cvt_pk_bf16_f32 v200, v176, v177
    v_mfma_f32_16x16x32_bf16 v[180:183], v[244:247], v[108:111], v[180:183]
    v_exp_f32 v178, v178
    v_mfma_f32_16x16x32_bf16 v[188:191], v[244:247], v[124:127], v[188:191]
    ds_read_b128 v[240:243], v250 offset:35840
    v_mfma_f32_16x16x32_bf16 v[216:219], v[224:227], v[192:195], v[216:219]
    v_exp_f32 v179, v179
    v_mfma_f32_16x16x32_bf16 v[220:223], v[224:227], v[196:199], v[220:223]
    s_waitcnt lgkmcnt(2)
    v_mfma_f32_16x16x32_bf16 v[0:3], v[228:231], v[192:195], v[0:3]
    v_exp_f32 v184, v184
    v_mfma_f32_16x16x32_bf16 v[32:35], v[228:231], v[196:199], v[32:35]
    ds_read_b128 v[244:247], v250 offset:36864
    v_cvt_pk_bf16_f32 v201, v178, v179
    v_mfma_f32_16x16x32_bf16 v[4:7], v[232:235], v[192:195], v[4:7]
    v_exp_f32 v185, v185
    v_mfma_f32_16x16x32_bf16 v[36:39], v[232:235], v[196:199], v[36:39]
    ds_read_b128 v[228:231], v250 offset:37888
    s_waitcnt lgkmcnt(2)
    v_mfma_f32_16x16x32_bf16 v[8:11], v[236:239], v[192:195], v[8:11]
    v_exp_f32 v186, v186
    v_mfma_f32_16x16x32_bf16 v[40:43], v[236:239], v[196:199], v[40:43]
    ds_read_b128 v[232:235], v250 offset:38912
    v_cvt_pk_bf16_f32 v204, v184, v185
    v_mfma_f32_16x16x32_bf16 v[12:15], v[240:243], v[192:195], v[12:15]
    v_exp_f32 v187, v187
    v_mfma_f32_16x16x32_bf16 v[44:47], v[240:243], v[196:199], v[44:47]
    ds_read_b128 v[236:239], v250 offset:39936
    s_waitcnt lgkmcnt(2)
    v_mfma_f32_16x16x32_bf16 v[16:19], v[244:247], v[192:195], v[16:19]
    v_exp_f32 v180, v180
    v_mfma_f32_16x16x32_bf16 v[48:51], v[244:247], v[196:199], v[48:51]
    ds_read_b128 v[240:243], v248 offset:49152
    v_cvt_pk_bf16_f32 v205, v186, v187
    v_mfma_f32_16x16x32_bf16 v[20:23], v[228:231], v[192:195], v[20:23]
    v_exp_f32 v181, v181
    v_mfma_f32_16x16x32_bf16 v[52:55], v[228:231], v[196:199], v[52:55]
    ds_read_b128 v[244:247], v248 offset:50176
    s_waitcnt lgkmcnt(2)
    v_mfma_f32_16x16x32_bf16 v[24:27], v[232:235], v[192:195], v[24:27]
    v_exp_f32 v182, v182
    v_mfma_f32_16x16x32_bf16 v[56:59], v[232:235], v[196:199], v[56:59]
    ds_read_b128 v[228:231], v248 offset:51200
    v_cvt_pk_bf16_f32 v202, v180, v181
    v_mfma_f32_16x16x32_bf16 v[28:31], v[236:239], v[192:195], v[28:31]
    v_exp_f32 v183, v183
    v_mfma_f32_16x16x32_bf16 v[60:63], v[236:239], v[196:199], v[60:63]
    ds_read_b128 v[232:235], v248 offset:52224
    buffer_store_dwordx4 v[72:75], v252, s[16:19], s21 offen offset:128 sc1
    buffer_store_dwordx4 v[76:79], v252, s[16:19], s21 offen offset:192 sc1
    s_waitcnt lgkmcnt(2)
    v_mfma_f32_16x16x32_bf16 v[160:163], v[240:243], v[96:99], v[208:211]
    v_exp_f32 v188, v188
    v_mfma_f32_16x16x32_bf16 v[168:171], v[240:243], v[112:115], v[212:215]
    ds_read_b128 v[236:239], v248 offset:53248
    v_cvt_pk_bf16_f32 v203, v182, v183
    v_mfma_f32_16x16x32_bf16 v[160:163], v[244:247], v[100:103], v[160:163]
    v_exp_f32 v189, v189
    v_mfma_f32_16x16x32_bf16 v[168:171], v[244:247], v[116:119], v[168:171]
    ds_read_b128 v[240:243], v248 offset:54272
    s_waitcnt lgkmcnt(2)
    v_mfma_f32_16x16x32_bf16 v[160:163], v[228:231], v[104:107], v[160:163]
    v_exp_f32 v190, v190
    v_mfma_f32_16x16x32_bf16 v[168:171], v[228:231], v[120:123], v[168:171]
    ds_read_b128 v[244:247], v248 offset:55296
    v_cvt_pk_bf16_f32 v206, v188, v189
    v_mfma_f32_16x16x32_bf16 v[160:163], v[232:235], v[108:111], v[160:163]
    v_exp_f32 v191, v191
    v_mfma_f32_16x16x32_bf16 v[168:171], v[232:235], v[124:127], v[168:171]
    ds_read_b128 v[228:231], v248 offset:56320
    s_waitcnt lgkmcnt(2)
    v_mfma_f32_16x16x32_bf16 v[164:167], v[236:239], v[96:99], v[208:211]
    v_cvt_pk_bf16_f32 v207, v190, v191
    v_mfma_f32_16x16x32_bf16 v[172:175], v[236:239], v[112:115], v[212:215]
    ds_read_b128 v[232:235], v250 offset:40960
    v_mfma_f32_16x16x32_bf16 v[164:167], v[240:243], v[100:103], v[164:167]
    v_exp_f32 v160, v160
    v_mfma_f32_16x16x32_bf16 v[172:175], v[240:243], v[116:119], v[172:175]
    ds_read_b128 v[236:239], v250 offset:41984
    s_waitcnt lgkmcnt(2)
    v_mfma_f32_16x16x32_bf16 v[164:167], v[244:247], v[104:107], v[164:167]
    v_exp_f32 v161, v161
    v_mfma_f32_16x16x32_bf16 v[172:175], v[244:247], v[120:123], v[172:175]
    ds_read_b128 v[240:243], v250 offset:43008
    v_cvt_pk_bf16_f32 v192, v160, v161
    v_mfma_f32_16x16x32_bf16 v[164:167], v[228:231], v[108:111], v[164:167]
    v_exp_f32 v162, v162
    v_mfma_f32_16x16x32_bf16 v[172:175], v[228:231], v[124:127], v[172:175]
    ds_read_b128 v[244:247], v250 offset:44032
    v_mfma_f32_16x16x32_bf16 v[216:219], v[224:227], v[200:203], v[216:219]
    v_exp_f32 v163, v163
    v_mfma_f32_16x16x32_bf16 v[220:223], v[224:227], v[204:207], v[220:223]
    s_waitcnt lgkmcnt(2)
    v_mfma_f32_16x16x32_bf16 v[0:3], v[232:235], v[200:203], v[0:3]
    v_exp_f32 v168, v168
    v_mfma_f32_16x16x32_bf16 v[32:35], v[232:235], v[204:207], v[32:35]
    ds_read_b128 v[228:231], v250 offset:45056
    v_cvt_pk_bf16_f32 v193, v162, v163
    v_mfma_f32_16x16x32_bf16 v[4:7], v[236:239], v[200:203], v[4:7]
    v_exp_f32 v169, v169
    v_mfma_f32_16x16x32_bf16 v[36:39], v[236:239], v[204:207], v[36:39]
    ds_read_b128 v[232:235], v250 offset:46080
    s_waitcnt lgkmcnt(2)
    v_mfma_f32_16x16x32_bf16 v[8:11], v[240:243], v[200:203], v[8:11]
    v_exp_f32 v170, v170
    v_mfma_f32_16x16x32_bf16 v[40:43], v[240:243], v[204:207], v[40:43]
    ds_read_b128 v[236:239], v250 offset:47104
    v_cvt_pk_bf16_f32 v196, v168, v169
    v_mfma_f32_16x16x32_bf16 v[12:15], v[244:247], v[200:203], v[12:15]
    v_exp_f32 v171, v171
    v_mfma_f32_16x16x32_bf16 v[44:47], v[244:247], v[204:207], v[44:47]
    ds_read_b128 v[240:243], v250 offset:48128
    s_waitcnt lgkmcnt(2)
    v_mfma_f32_16x16x32_bf16 v[16:19], v[228:231], v[200:203], v[16:19]
    v_exp_f32 v164, v164
    v_mfma_f32_16x16x32_bf16 v[48:51], v[228:231], v[204:207], v[48:51]
    ds_read_b128 v[244:247], v248 offset:57344
    v_cvt_pk_bf16_f32 v197, v170, v171
    v_mfma_f32_16x16x32_bf16 v[20:23], v[232:235], v[200:203], v[20:23]
    v_exp_f32 v165, v165
    v_mfma_f32_16x16x32_bf16 v[52:55], v[232:235], v[204:207], v[52:55]
    ds_read_b128 v[228:231], v248 offset:58368
    s_waitcnt lgkmcnt(2)
    v_mfma_f32_16x16x32_bf16 v[24:27], v[236:239], v[200:203], v[24:27]
    v_exp_f32 v166, v166
    v_mfma_f32_16x16x32_bf16 v[56:59], v[236:239], v[204:207], v[56:59]
    ds_read_b128 v[232:235], v248 offset:59392
    v_cvt_pk_bf16_f32 v194, v164, v165
    v_mfma_f32_16x16x32_bf16 v[28:31], v[240:243], v[200:203], v[28:31]
    v_exp_f32 v167, v167
    v_mfma_f32_16x16x32_bf16 v[60:63], v[240:243], v[204:207], v[60:63]
    ds_read_b128 v[236:239], v248 offset:60416
    s_waitcnt lgkmcnt(2)
    v_mfma_f32_16x16x32_bf16 v[176:179], v[244:247], v[96:99], v[208:211]
    v_exp_f32 v172, v172
    v_mfma_f32_16x16x32_bf16 v[184:187], v[244:247], v[112:115], v[212:215]
    ds_read_b128 v[240:243], v248 offset:61440
    v_cvt_pk_bf16_f32 v195, v166, v167
    v_mfma_f32_16x16x32_bf16 v[176:179], v[228:231], v[100:103], v[176:179]
    v_exp_f32 v173, v173
    v_mfma_f32_16x16x32_bf16 v[184:187], v[228:231], v[116:119], v[184:187]
    ds_read_b128 v[244:247], v248 offset:62464
    s_waitcnt lgkmcnt(2)
    v_mfma_f32_16x16x32_bf16 v[176:179], v[232:235], v[104:107], v[176:179]
    v_exp_f32 v174, v174
    v_mfma_f32_16x16x32_bf16 v[184:187], v[232:235], v[120:123], v[184:187]
    ds_read_b128 v[228:231], v248 offset:63488
    v_cvt_pk_bf16_f32 v198, v172, v173
    v_mfma_f32_16x16x32_bf16 v[176:179], v[236:239], v[108:111], v[176:179]
    v_exp_f32 v175, v175
    v_mfma_f32_16x16x32_bf16 v[184:187], v[236:239], v[124:127], v[184:187]
    ds_read_b128 v[232:235], v248 offset:64512
    s_waitcnt lgkmcnt(2)
    v_mfma_f32_16x16x32_bf16 v[180:183], v[240:243], v[96:99], v[208:211]
    v_cvt_pk_bf16_f32 v199, v174, v175
    v_mfma_f32_16x16x32_bf16 v[188:191], v[240:243], v[112:115], v[212:215]
    ds_read_b128 v[236:239], v250 offset:49152
    v_mfma_f32_16x16x32_bf16 v[180:183], v[244:247], v[100:103], v[180:183]
    v_exp_f32 v176, v176
    v_mfma_f32_16x16x32_bf16 v[188:191], v[244:247], v[116:119], v[188:191]
    ds_read_b128 v[240:243], v250 offset:50176
    buffer_store_dwordx4 v[80:83], v252, s[16:19], s22 offen offset:0 sc1
    buffer_store_dwordx4 v[84:87], v252, s[16:19], s22 offen offset:64 sc1
    s_waitcnt lgkmcnt(2)
    v_mfma_f32_16x16x32_bf16 v[180:183], v[228:231], v[104:107], v[180:183]
    v_exp_f32 v177, v177
    v_mfma_f32_16x16x32_bf16 v[188:191], v[228:231], v[120:123], v[188:191]
    ds_read_b128 v[244:247], v250 offset:51200
    v_cvt_pk_bf16_f32 v200, v176, v177
    v_mfma_f32_16x16x32_bf16 v[180:183], v[232:235], v[108:111], v[180:183]
    v_exp_f32 v178, v178
    v_mfma_f32_16x16x32_bf16 v[188:191], v[232:235], v[124:127], v[188:191]
    ds_read_b128 v[228:231], v250 offset:52224
    v_mfma_f32_16x16x32_bf16 v[216:219], v[224:227], v[192:195], v[216:219]
    v_exp_f32 v179, v179
    v_mfma_f32_16x16x32_bf16 v[220:223], v[224:227], v[196:199], v[220:223]
    s_waitcnt lgkmcnt(2)
    v_mfma_f32_16x16x32_bf16 v[0:3], v[236:239], v[192:195], v[0:3]
    v_exp_f32 v184, v184
    v_mfma_f32_16x16x32_bf16 v[32:35], v[236:239], v[196:199], v[32:35]
    ds_read_b128 v[232:235], v250 offset:53248
    v_cvt_pk_bf16_f32 v201, v178, v179
    v_mfma_f32_16x16x32_bf16 v[4:7], v[240:243], v[192:195], v[4:7]
    v_exp_f32 v185, v185
    v_mfma_f32_16x16x32_bf16 v[36:39], v[240:243], v[196:199], v[36:39]
    ds_read_b128 v[236:239], v250 offset:54272
    s_waitcnt lgkmcnt(2)
    v_mfma_f32_16x16x32_bf16 v[8:11], v[244:247], v[192:195], v[8:11]
    v_exp_f32 v186, v186
    v_mfma_f32_16x16x32_bf16 v[40:43], v[244:247], v[196:199], v[40:43]
    ds_read_b128 v[240:243], v250 offset:55296
    v_cvt_pk_bf16_f32 v204, v184, v185
    v_mfma_f32_16x16x32_bf16 v[12:15], v[228:231], v[192:195], v[12:15]
    v_exp_f32 v187, v187
    v_mfma_f32_16x16x32_bf16 v[44:47], v[228:231], v[196:199], v[44:47]
    ds_read_b128 v[244:247], v250 offset:56320
    s_waitcnt lgkmcnt(2)
    v_mfma_f32_16x16x32_bf16 v[16:19], v[232:235], v[192:195], v[16:19]
    v_exp_f32 v180, v180
    v_mfma_f32_16x16x32_bf16 v[48:51], v[232:235], v[196:199], v[48:51]
    ds_read_b128 v[228:231], v249 offset:0
    v_cvt_pk_bf16_f32 v205, v186, v187
    v_mfma_f32_16x16x32_bf16 v[20:23], v[236:239], v[192:195], v[20:23]
    v_exp_f32 v181, v181
    v_mfma_f32_16x16x32_bf16 v[52:55], v[236:239], v[196:199], v[52:55]
    ds_read_b128 v[232:235], v249 offset:1024
    s_waitcnt lgkmcnt(2)
    v_mfma_f32_16x16x32_bf16 v[24:27], v[240:243], v[192:195], v[24:27]
    v_exp_f32 v182, v182
    v_mfma_f32_16x16x32_bf16 v[56:59], v[240:243], v[196:199], v[56:59]
    ds_read_b128 v[236:239], v249 offset:2048
    v_cvt_pk_bf16_f32 v202, v180, v181
    v_mfma_f32_16x16x32_bf16 v[28:31], v[244:247], v[192:195], v[28:31]
    v_exp_f32 v183, v183
    v_mfma_f32_16x16x32_bf16 v[60:63], v[244:247], v[196:199], v[60:63]
    ds_read_b128 v[240:243], v249 offset:3072
    s_waitcnt lgkmcnt(2)
    v_mfma_f32_16x16x32_bf16 v[160:163], v[228:231], v[96:99], v[208:211]
    v_exp_f32 v188, v188
    v_mfma_f32_16x16x32_bf16 v[168:171], v[228:231], v[112:115], v[212:215]
    ds_read_b128 v[244:247], v249 offset:4096
    v_cvt_pk_bf16_f32 v203, v182, v183
    v_mfma_f32_16x16x32_bf16 v[160:163], v[232:235], v[100:103], v[160:163]
    v_exp_f32 v189, v189
    v_mfma_f32_16x16x32_bf16 v[168:171], v[232:235], v[116:119], v[168:171]
    ds_read_b128 v[228:231], v249 offset:5120
    s_waitcnt lgkmcnt(2)
    v_mfma_f32_16x16x32_bf16 v[160:163], v[236:239], v[104:107], v[160:163]
    v_exp_f32 v190, v190
    v_mfma_f32_16x16x32_bf16 v[168:171], v[236:239], v[120:123], v[168:171]
    ds_read_b128 v[232:235], v249 offset:6144
    v_cvt_pk_bf16_f32 v206, v188, v189
    v_mfma_f32_16x16x32_bf16 v[160:163], v[240:243], v[108:111], v[160:163]
    v_exp_f32 v191, v191
    v_mfma_f32_16x16x32_bf16 v[168:171], v[240:243], v[124:127], v[168:171]
    ds_read_b128 v[236:239], v249 offset:7168
    s_waitcnt lgkmcnt(2)
    v_mfma_f32_16x16x32_bf16 v[164:167], v[244:247], v[96:99], v[208:211]
    v_cvt_pk_bf16_f32 v207, v190, v191
    v_mfma_f32_16x16x32_bf16 v[172:175], v[244:247], v[112:115], v[212:215]
    ds_read_b128 v[240:243], v250 offset:57344
    v_mfma_f32_16x16x32_bf16 v[164:167], v[228:231], v[100:103], v[164:167]
    v_exp_f32 v160, v160
    v_mfma_f32_16x16x32_bf16 v[172:175], v[228:231], v[116:119], v[172:175]
    ds_read_b128 v[244:247], v250 offset:58368
    s_waitcnt lgkmcnt(2)
    v_mfma_f32_16x16x32_bf16 v[164:167], v[232:235], v[104:107], v[164:167]
    v_exp_f32 v161, v161
    v_mfma_f32_16x16x32_bf16 v[172:175], v[232:235], v[120:123], v[172:175]
    ds_read_b128 v[228:231], v250 offset:59392
    v_cvt_pk_bf16_f32 v192, v160, v161
    v_mfma_f32_16x16x32_bf16 v[164:167], v[236:239], v[108:111], v[164:167]
    v_exp_f32 v162, v162
    v_mfma_f32_16x16x32_bf16 v[172:175], v[236:239], v[124:127], v[172:175]
    ds_read_b128 v[232:235], v250 offset:60416
    v_mfma_f32_16x16x32_bf16 v[216:219], v[224:227], v[200:203], v[216:219]
    v_exp_f32 v163, v163
    v_mfma_f32_16x16x32_bf16 v[220:223], v[224:227], v[204:207], v[220:223]
    s_waitcnt lgkmcnt(2)
    v_mfma_f32_16x16x32_bf16 v[0:3], v[240:243], v[200:203], v[0:3]
    v_exp_f32 v168, v168
    v_mfma_f32_16x16x32_bf16 v[32:35], v[240:243], v[204:207], v[32:35]
    ds_read_b128 v[236:239], v250 offset:61440
    v_cvt_pk_bf16_f32 v193, v162, v163
    v_mfma_f32_16x16x32_bf16 v[4:7], v[244:247], v[200:203], v[4:7]
    v_exp_f32 v169, v169
    v_mfma_f32_16x16x32_bf16 v[36:39], v[244:247], v[204:207], v[36:39]
    ds_read_b128 v[240:243], v250 offset:62464
    s_waitcnt lgkmcnt(2)
    v_mfma_f32_16x16x32_bf16 v[8:11], v[228:231], v[200:203], v[8:11]
    v_exp_f32 v170, v170
    v_mfma_f32_16x16x32_bf16 v[40:43], v[228:231], v[204:207], v[40:43]
    ds_read_b128 v[244:247], v250 offset:63488
    v_cvt_pk_bf16_f32 v196, v168, v169
    v_mfma_f32_16x16x32_bf16 v[12:15], v[232:235], v[200:203], v[12:15]
    v_exp_f32 v171, v171
    v_mfma_f32_16x16x32_bf16 v[44:47], v[232:235], v[204:207], v[44:47]
    ds_read_b128 v[228:231], v250 offset:64512
    buffer_store_dwordx4 v[88:91], v252, s[16:19], s22 offen offset:128 sc1
    buffer_store_dwordx4 v[92:95], v252, s[16:19], s22 offen offset:192 sc1
    s_waitcnt lgkmcnt(2)
    v_mfma_f32_16x16x32_bf16 v[16:19], v[236:239], v[200:203], v[16:19]
    v_exp_f32 v164, v164
    v_mfma_f32_16x16x32_bf16 v[48:51], v[236:239], v[204:207], v[48:51]
    ds_read_b128 v[232:235], v249 offset:8192
    v_cvt_pk_bf16_f32 v197, v170, v171
    v_mfma_f32_16x16x32_bf16 v[20:23], v[240:243], v[200:203], v[20:23]
    v_exp_f32 v165, v165
    v_mfma_f32_16x16x32_bf16 v[52:55], v[240:243], v[204:207], v[52:55]
    ds_read_b128 v[236:239], v249 offset:9216
    s_waitcnt lgkmcnt(2)
    v_mfma_f32_16x16x32_bf16 v[24:27], v[244:247], v[200:203], v[24:27]
    v_exp_f32 v166, v166
    v_mfma_f32_16x16x32_bf16 v[56:59], v[244:247], v[204:207], v[56:59]
    ds_read_b128 v[240:243], v249 offset:10240
    v_cvt_pk_bf16_f32 v194, v164, v165
    v_mfma_f32_16x16x32_bf16 v[28:31], v[228:231], v[200:203], v[28:31]
    v_exp_f32 v167, v167
    v_mfma_f32_16x16x32_bf16 v[60:63], v[228:231], v[204:207], v[60:63]
    ds_read_b128 v[244:247], v249 offset:11264
    s_waitcnt lgkmcnt(2)
    v_mfma_f32_16x16x32_bf16 v[176:179], v[232:235], v[96:99], v[208:211]
    v_exp_f32 v172, v172
    v_cvt_pk_bf16_f32 v195, v166, v167
    v_mfma_f32_16x16x32_bf16 v[184:187], v[232:235], v[112:115], v[212:215]
    ds_read_b128 v[228:231], v249 offset:12288
    v_exp_f32 v173, v173
    v_mfma_f32_16x16x32_bf16 v[176:179], v[236:239], v[100:103], v[176:179]
    v_exp_f32 v174, v174
    v_cvt_pk_bf16_f32 v198, v172, v173
    v_mfma_f32_16x16x32_bf16 v[184:187], v[236:239], v[116:119], v[184:187]
    ds_read_b128 v[232:235], v249 offset:13312
    s_waitcnt lgkmcnt(2)
    v_mfma_f32_16x16x32_bf16 v[176:179], v[240:243], v[104:107], v[176:179]
    v_exp_f32 v175, v175
    v_mfma_f32_16x16x32_bf16 v[184:187], v[240:243], v[120:123], v[184:187]
    ds_read_b128 v[236:239], v249 offset:14336
    v_cvt_pk_bf16_f32 v199, v174, v175
    v_mfma_f32_16x16x32_bf16 v[176:179], v[244:247], v[108:111], v[176:179]
    v_mfma_f32_16x16x32_bf16 v[184:187], v[244:247], v[124:127], v[184:187]
    ds_read_b128 v[240:243], v249 offset:15360
    s_waitcnt lgkmcnt(2)
    v_mfma_f32_16x16x32_bf16 v[180:183], v[228:231], v[96:99], v[208:211]
    v_mfma_f32_16x16x32_bf16 v[188:191], v[228:231], v[112:115], v[212:215]
    ds_read_b128 v[244:247], v251 offset:0
    v_mfma_f32_16x16x32_bf16 v[180:183], v[232:235], v[100:103], v[180:183]
    s_nop 0
    v_exp_f32 v176, v176
    v_mfma_f32_16x16x32_bf16 v[188:191], v[232:235], v[116:119], v[188:191]
    ds_read_b128 v[228:231], v251 offset:1024
    s_waitcnt lgkmcnt(2)
    v_mfma_f32_16x16x32_bf16 v[180:183], v[236:239], v[104:107], v[180:183]
    v_exp_f32 v177, v177
    v_mfma_f32_16x16x32_bf16 v[188:191], v[236:239], v[120:123], v[188:191]
    ds_read_b128 v[232:235], v251 offset:2048
    v_cvt_pk_bf16_f32 v200, v176, v177
    v_mfma_f32_16x16x32_bf16 v[180:183], v[240:243], v[108:111], v[180:183]
    v_exp_f32 v178, v178
    v_mfma_f32_16x16x32_bf16 v[188:191], v[240:243], v[124:127], v[188:191]
    ds_read_b128 v[236:239], v251 offset:3072
    v_mfma_f32_16x16x32_bf16 v[216:219], v[224:227], v[192:195], v[216:219]
    v_exp_f32 v179, v179
    v_mfma_f32_16x16x32_bf16 v[220:223], v[224:227], v[196:199], v[220:223]
    s_waitcnt lgkmcnt(2)
    v_mfma_f32_16x16x32_bf16 v[0:3], v[244:247], v[192:195], v[0:3]
    v_exp_f32 v184, v184
    v_cvt_pk_bf16_f32 v201, v178, v179
    v_mfma_f32_16x16x32_bf16 v[32:35], v[244:247], v[196:199], v[32:35]
    ds_read_b128 v[240:243], v251 offset:4096
    v_exp_f32 v185, v185
    v_mfma_f32_16x16x32_bf16 v[4:7], v[228:231], v[192:195], v[4:7]
    v_exp_f32 v186, v186
    v_cvt_pk_bf16_f32 v204, v184, v185
    v_mfma_f32_16x16x32_bf16 v[36:39], v[228:231], v[196:199], v[36:39]
    ds_read_b128 v[244:247], v251 offset:5120
    s_waitcnt lgkmcnt(2)
    v_mfma_f32_16x16x32_bf16 v[8:11], v[232:235], v[192:195], v[8:11]
    v_exp_f32 v187, v187
    v_mfma_f32_16x16x32_bf16 v[40:43], v[232:235], v[196:199], v[40:43]
    ds_read_b128 v[228:231], v251 offset:6144
    v_cvt_pk_bf16_f32 v205, v186, v187
    v_mfma_f32_16x16x32_bf16 v[12:15], v[236:239], v[192:195], v[12:15]
    v_exp_f32 v180, v180
    v_mfma_f32_16x16x32_bf16 v[44:47], v[236:239], v[196:199], v[44:47]
    ds_read_b128 v[232:235], v251 offset:7168
    s_waitcnt lgkmcnt(2)
    v_mfma_f32_16x16x32_bf16 v[16:19], v[240:243], v[192:195], v[16:19]
    v_exp_f32 v181, v181
    v_exp_f32 v182, v182
    v_mfma_f32_16x16x32_bf16 v[48:51], v[240:243], v[196:199], v[48:51]
    ds_read_b128 v[236:239], v251 offset:8192
    v_cvt_pk_bf16_f32 v202, v180, v181
    v_mfma_f32_16x16x32_bf16 v[20:23], v[244:247], v[192:195], v[20:23]
    v_exp_f32 v183, v183
    v_exp_f32 v188, v188
    v_mfma_f32_16x16x32_bf16 v[52:55], v[244:247], v[196:199], v[52:55]
    ds_read_b128 v[240:243], v251 offset:9216
    v_cvt_pk_bf16_f32 v203, v182, v183
    s_waitcnt lgkmcnt(2)
    v_mfma_f32_16x16x32_bf16 v[24:27], v[228:231], v[192:195], v[24:27]
    v_exp_f32 v189, v189
    v_mfma_f32_16x16x32_bf16 v[56:59], v[228:231], v[196:199], v[56:59]
    ds_read_b128 v[244:247], v251 offset:10240
    v_cvt_pk_bf16_f32 v206, v188, v189
    v_exp_f32 v190, v190
    v_mfma_f32_16x16x32_bf16 v[28:31], v[232:235], v[192:195], v[28:31]
    v_exp_f32 v191, v191
    v_mfma_f32_16x16x32_bf16 v[60:63], v[232:235], v[196:199], v[60:63]
    ds_read_b128 v[228:231], v251 offset:11264
    v_cvt_pk_bf16_f32 v207, v190, v191
    v_mfma_f32_16x16x32_bf16 v[216:219], v[224:227], v[200:203], v[216:219]
    s_nop 0
    v_mfma_f32_16x16x32_bf16 v[220:223], v[224:227], v[204:207], v[220:223]
    s_waitcnt lgkmcnt(2)
    v_mfma_f32_16x16x32_bf16 v[0:3], v[236:239], v[200:203], v[0:3]
    v_mfma_f32_16x16x32_bf16 v[32:35], v[236:239], v[204:207], v[32:35]
    ds_read_b128 v[232:235], v251 offset:12288
    v_mfma_f32_16x16x32_bf16 v[4:7], v[240:243], v[200:203], v[4:7]
    v_mfma_f32_16x16x32_bf16 v[36:39], v[240:243], v[204:207], v[36:39]
    ds_read_b128 v[236:239], v251 offset:13312
    s_waitcnt lgkmcnt(2)
    v_mfma_f32_16x16x32_bf16 v[8:11], v[244:247], v[200:203], v[8:11]
    v_mfma_f32_16x16x32_bf16 v[40:43], v[244:247], v[204:207], v[40:43]
    ds_read_b128 v[240:243], v251 offset:14336
    v_mfma_f32_16x16x32_bf16 v[12:15], v[228:231], v[200:203], v[12:15]
    v_mfma_f32_16x16x32_bf16 v[44:47], v[228:231], v[204:207], v[44:47]
    ds_read_b128 v[244:247], v251 offset:15360
    s_waitcnt lgkmcnt(2)
    v_mfma_f32_16x16x32_bf16 v[16:19], v[232:235], v[200:203], v[16:19]
    v_mfma_f32_16x16x32_bf16 v[48:51], v[232:235], v[204:207], v[48:51]
    v_mfma_f32_16x16x32_bf16 v[20:23], v[236:239], v[200:203], v[20:23]
    v_mfma_f32_16x16x32_bf16 v[52:55], v[236:239], v[204:207], v[52:55]
    s_waitcnt lgkmcnt(0)
    v_mfma_f32_16x16x32_bf16 v[24:27], v[240:243], v[200:203], v[24:27]
    v_mfma_f32_16x16x32_bf16 v[56:59], v[240:243], v[204:207], v[56:59]
    v_mfma_f32_16x16x32_bf16 v[28:31], v[244:247], v[200:203], v[28:31]
    v_mfma_f32_16x16x32_bf16 v[60:63], v[244:247], v[204:207], v[60:63]
    s_setprio 0
    v_cmp_gt_f32 vcc, s29, v216
    v_cmp_gt_f32 s[38:39], s29, v220
    s_nop 0
    s_and_b64 vcc, vcc, s[38:39]
    s_cmp_eq_u64 vcc, -1
    s_cbranch_scc0 L_fix1
L_ok1:
    s_waitcnt vmcnt(8)
    v_rcp_f32 v253, v216
    v_rcp_f32 v254, v220
    v_mul_f32 v0, v0, v253
    v_mul_f32 v1, v1, v253
    v_mul_f32 v2, v2, v253
    v_mul_f32 v3, v3, v253
    v_mul_f32 v4, v4, v253
    v_mul_f32 v5, v5, v253
    v_mul_f32 v6, v6, v253
    v_mul_f32 v7, v7, v253
    v_cvt_pk_bf16_f32 v96, v0, v1
    v_cvt_pk_bf16_f32 v97, v2, v3
    v_cvt_pk_bf16_f32 v98, v4, v5
    v_cvt_pk_bf16_f32 v99, v6, v7
    buffer_store_dwordx4 v[96:99], v252, s[16:19], s23 offen offset:0 sc1
    v_mul_f32 v8, v8, v253
    v_mul_f32 v9, v9, v253
    v_mul_f32 v10, v10, v253
    v_mul_f32 v11, v11, v253
    v_mul_f32 v12, v12, v253
    v_mul_f32 v13, v13, v253
    v_mul_f32 v14, v14, v253
    v_mul_f32 v15, v15, v253
    v_cvt_pk_bf16_f32 v100, v8, v9
    v_cvt_pk_bf16_f32 v101, v10, v11
    v_cvt_pk_bf16_f32 v102, v12, v13
    v_cvt_pk_bf16_f32 v103, v14, v15
    buffer_store_dwordx4 v[100:103], v252, s[16:19], s23 offen offset:64 sc1
    v_mul_f32 v32, v32, v254
    v_mul_f32 v33, v33, v254
    v_mul_f32 v34, v34, v254
    v_mul_f32 v35, v35, v254
    v_mul_f32 v36, v36, v254
    v_mul_f32 v37, v37, v254
    v_mul_f32 v38, v38, v254
    v_mul_f32 v39, v39, v254
    v_cvt_pk_bf16_f32 v112, v32, v33
    v_cvt_pk_bf16_f32 v113, v34, v35
    v_cvt_pk_bf16_f32 v114, v36, v37
    v_cvt_pk_bf16_f32 v115, v38, v39
    buffer_store_dwordx4 v[112:115], v252, s[16:19], s24 offen offset:0 sc1
    v_mul_f32 v40, v40, v254
    v_mul_f32 v41, v41, v254
    v_mul_f32 v42, v42, v254
    v_mul_f32 v43, v43, v254
    v_mul_f32 v44, v44, v254
    v_mul_f32 v45, v45, v254
    v_mul_f32 v46, v46, v254
    v_mul_f32 v47, v47, v254
    v_cvt_pk_bf16_f32 v116, v40, v41
    v_cvt_pk_bf16_f32 v117, v42, v43
    v_cvt_pk_bf16_f32 v118, v44, v45
    v_cvt_pk_bf16_f32 v119, v46, v47
    buffer_store_dwordx4 v[116:119], v252, s[16:19], s24 offen offset:64 sc1
    v_mul_f32 v16, v16, v253
    v_mul_f32 v17, v17, v253
    v_mul_f32 v18, v18, v253
    v_mul_f32 v19, v19, v253
    v_mul_f32 v20, v20, v253
    v_mul_f32 v21, v21, v253
    v_mul_f32 v22, v22, v253
    v_mul_f32 v23, v23, v253
    v_cvt_pk_bf16_f32 v104, v16, v17
    v_cvt_pk_bf16_f32 v105, v18, v19
    v_cvt_pk_bf16_f32 v106, v20, v21
    v_cvt_pk_bf16_f32 v107, v22, v23
    buffer_store_dwordx4 v[104:107], v252, s[16:19], s23 offen offset:128 sc1
    v_mul_f32 v24, v24, v253
    v_mul_f32 v25, v25, v253
    v_mul_f32 v26, v26, v253
    v_mul_f32 v27, v27, v253
    v_mul_f32 v28, v28, v253
    v_mul_f32 v29, v29, v253
    v_mul_f32 v30, v30, v253
    v_mul_f32 v31, v31, v253
    v_cvt_pk_bf16_f32 v108, v24, v25
    v_cvt_pk_bf16_f32 v109, v26, v27
    v_cvt_pk_bf16_f32 v110, v28, v29
    v_cvt_pk_bf16_f32 v111, v30, v31
    buffer_store_dwordx4 v[108:111], v252, s[16:19], s23 offen offset:192 sc1
    v_mul_f32 v48, v48, v254
    v_mul_f32 v49, v49, v254
    v_mul_f32 v50, v50, v254
    v_mul_f32 v51, v51, v254
    v_mul_f32 v52, v52, v254
    v_mul_f32 v53, v53, v254
    v_mul_f32 v54, v54, v254
    v_mul_f32 v55, v55, v254
    v_cvt_pk_bf16_f32 v120, v48, v49
    v_cvt_pk_bf16_f32 v121, v50, v51
    v_cvt_pk_bf16_f32 v122, v52, v53
    v_cvt_pk_bf16_f32 v123, v54, v55
    buffer_store_dwordx4 v[120:123], v252, s[16:19], s24 offen offset:128 sc1
    v_mul_f32 v56, v56, v254
    v_mul_f32 v57, v57, v254
    v_mul_f32 v58, v58, v254
    v_mul_f32 v59, v59, v254
    v_mul_f32 v60, v60, v254
    v_mul_f32 v61, v61, v254
    v_mul_f32 v62, v62, v254
    v_mul_f32 v63, v63, v254
    v_cvt_pk_bf16_f32 v124, v56, v57
    v_cvt_pk_bf16_f32 v125, v58, v59
    v_cvt_pk_bf16_f32 v126, v60, v61
    v_cvt_pk_bf16_f32 v127, v62, v63
    buffer_store_dwordx4 v[124:127], v252, s[16:19], s24 offen offset:192 sc1
    s_cmp_ge_u32 s20, 4
    s_cbranch_scc1 L_done
    ds_read_b128 v[228:231], v248 offset:0
    ds_read_b128 v[232:235], v248 offset:1024
    ds_read_b128 v[236:239], v248 offset:2048
    ds_read_b128 v[240:243], v248 offset:3072
    s_setprio 3
    s_waitcnt lgkmcnt(2)
    v_mfma_f32_16x16x32_bf16 v[160:163], v[228:231], v[128:131], 0
    v_mfma_f32_16x16x32_bf16 v[168:171], v[228:231], v[144:147], 0
    ds_read_b128 v[244:247], v248 offset:4096
    v_mfma_f32_16x16x32_bf16 v[160:163], v[232:235], v[132:135], v[160:163]
    v_mfma_f32_16x16x32_bf16 v[168:171], v[232:235], v[148:151], v[168:171]
    ds_read_b128 v[228:231], v248 offset:5120
    s_waitcnt lgkmcnt(2)
    v_mfma_f32_16x16x32_bf16 v[160:163], v[236:239], v[136:139], v[160:163]
    v_mfma_f32_16x16x32_bf16 v[168:171], v[236:239], v[152:155], v[168:171]
    ds_read_b128 v[232:235], v248 offset:6144
    v_mfma_f32_16x16x32_bf16 v[160:163], v[240:243], v[140:143], v[160:163]
    v_mfma_f32_16x16x32_bf16 v[168:171], v[240:243], v[156:159], v[168:171]
    ds_read_b128 v[236:239], v248 offset:7168
    s_waitcnt lgkmcnt(2)
    v_mfma_f32_16x16x32_bf16 v[164:167], v[244:247], v[128:131], 0
    v_mfma_f32_16x16x32_bf16 v[172:175], v[244:247], v[144:147], 0
    ds_read_b128 v[240:243], v248 offset:8192
    v_mfma_f32_16x16x32_bf16 v[164:167], v[228:231], v[132:135], v[164:167]
    v_mfma_f32_16x16x32_bf16 v[172:175], v[228:231], v[148:151], v[172:175]
    ds_read_b128 v[244:247], v248 offset:9216
    s_waitcnt lgkmcnt(2)
    v_mfma_f32_16x16x32_bf16 v[164:167], v[232:235], v[136:139], v[164:167]
    v_mfma_f32_16x16x32_bf16 v[172:175], v[232:235], v[152:155], v[172:175]
    ds_read_b128 v[228:231], v248 offset:10240
    v_mfma_f32_16x16x32_bf16 v[164:167], v[236:239], v[140:143], v[164:167]
    v_mfma_f32_16x16x32_bf16 v[172:175], v[236:239], v[156:159], v[172:175]
    ds_read_b128 v[232:235], v248 offset:11264
    s_waitcnt lgkmcnt(2)
    v_mfma_f32_16x16x32_bf16 v[176:179], v[240:243], v[128:131], 0
    v_mfma_f32_16x16x32_bf16 v[184:187], v[240:243], v[144:147], 0
    ds_read_b128 v[236:239], v248 offset:12288
    v_mfma_f32_16x16x32_bf16 v[176:179], v[244:247], v[132:135], v[176:179]
    v_mfma_f32_16x16x32_bf16 v[184:187], v[244:247], v[148:151], v[184:187]
    ds_read_b128 v[240:243], v248 offset:13312
    s_waitcnt lgkmcnt(2)
    v_mfma_f32_16x16x32_bf16 v[176:179], v[228:231], v[136:139], v[176:179]
    v_mfma_f32_16x16x32_bf16 v[184:187], v[228:231], v[152:155], v[184:187]
    ds_read_b128 v[244:247], v248 offset:14336
    v_mfma_f32_16x16x32_bf16 v[176:179], v[232:235], v[140:143], v[176:179]
    v_mfma_f32_16x16x32_bf16 v[184:187], v[232:235], v[156:159], v[184:187]
    ds_read_b128 v[228:231], v248 offset:15360
    s_waitcnt lgkmcnt(2)
    v_mfma_f32_16x16x32_bf16 v[180:183], v[236:239], v[128:131], 0
    v_mfma_f32_16x16x32_bf16 v[188:191], v[236:239], v[144:147], 0
    ds_read_b128 v[232:235], v250 offset:0
    v_mfma_f32_16x16x32_bf16 v[180:183], v[240:243], v[132:135], v[180:183]
    v_mfma_f32_16x16x32_bf16 v[188:191], v[240:243], v[148:151], v[188:191]
    ds_read_b128 v[236:239], v250 offset:1024
    s_waitcnt lgkmcnt(2)
    v_mfma_f32_16x16x32_bf16 v[180:183], v[244:247], v[136:139], v[180:183]
    v_mfma_f32_16x16x32_bf16 v[188:191], v[244:247], v[152:155], v[188:191]
    ds_read_b128 v[240:243], v250 offset:2048
    v_mfma_f32_16x16x32_bf16 v[180:183], v[228:231], v[140:143], v[180:183]
    v_mfma_f32_16x16x32_bf16 v[188:191], v[228:231], v[156:159], v[188:191]
    ds_read_b128 v[244:247], v250 offset:3072
    s_setprio 0
    v_max3_f32 v208, v160, v161, v162
    v_max3_f32 v212, v168, v169, v170
    v_max3_f32 v208, v163, v164, v208
    v_max3_f32 v212, v171, v172, v212
    v_max3_f32 v208, v165, v166, v208
    v_max3_f32 v212, v173, v174, v212
    v_max_f32 v208, v167, v208
    v_max_f32 v212, v175, v212
    s_nop 1
    v_permlane16_swap_b32 v208, v212
    v_max_f32 v208, v208, v212
    v_mov_b32 v212, v208
    s_nop 1
    v_permlane32_swap_b32 v208, v212
    v_max_f32 v208, v208, v212
    v_mov_b32 v212, v208
    s_nop 1
    v_permlane16_swap_b32 v208, v212
    v_sub_f32 v209, 0, v208
    v_sub_f32 v210, 0, v208
    v_sub_f32 v211, 0, v208
    v_sub_f32 v208, 0, v208
    v_sub_f32 v213, 0, v212
    v_sub_f32 v214, 0, v212
    v_sub_f32 v215, 0, v212
    v_sub_f32 v212, 0, v212
    v_add_f32 v160, v160, v208
    v_add_f32 v161, v161, v208
    v_exp_f32 v160, v160
    v_exp_f32 v161, v161
    v_add_f32 v162, v162, v208
    v_cvt_pk_bf16_f32 v192, v160, v161
    v_exp_f32 v162, v162
    v_add_f32 v163, v163, v208
    v_add_f32 v168, v168, v212
    v_exp_f32 v163, v163
    v_exp_f32 v168, v168
    v_cvt_pk_bf16_f32 v193, v162, v163
    v_add_f32 v169, v169, v212
    v_add_f32 v170, v170, v212
    v_exp_f32 v169, v169
    v_exp_f32 v170, v170
    v_cvt_pk_bf16_f32 v196, v168, v169
    v_add_f32 v171, v171, v212
    v_add_f32 v164, v164, v208
    v_exp_f32 v171, v171
    v_exp_f32 v164, v164
    v_cvt_pk_bf16_f32 v197, v170, v171
    v_add_f32 v165, v165, v208
    v_add_f32 v166, v166, v208
    v_exp_f32 v165, v165
    v_exp_f32 v166, v166
    v_cvt_pk_bf16_f32 v194, v164, v165
    v_add_f32 v167, v167, v208
    v_add_f32 v172, v172, v212
    v_exp_f32 v167, v167
    v_exp_f32 v172, v172
    v_cvt_pk_bf16_f32 v195, v166, v167
    v_add_f32 v173, v173, v212
    v_add_f32 v174, v174, v212
    v_exp_f32 v173, v173
    v_exp_f32 v174, v174
    v_cvt_pk_bf16_f32 v198, v172, v173
    v_add_f32 v175, v175, v212
    v_add_f32 v176, v176, v208
    v_exp_f32 v175, v175
    v_exp_f32 v176, v176
    v_cvt_pk_bf16_f32 v199, v174, v175
    v_add_f32 v177, v177, v208
    v_add_f32 v178, v178, v208
    v_exp_f32 v177, v177
    v_exp_f32 v178, v178
    v_cvt_pk_bf16_f32 v200, v176, v177
    v_add_f32 v179, v179, v208
    v_add_f32 v184, v184, v212
    v_exp_f32 v179, v179
    v_exp_f32 v184, v184
    v_cvt_pk_bf16_f32 v201, v178, v179
    v_add_f32 v185, v185, v212
    v_add_f32 v186, v186, v212
    v_exp_f32 v185, v185
    v_exp_f32 v186, v186
    v_cvt_pk_bf16_f32 v204, v184, v185
    v_add_f32 v187, v187, v212
    v_add_f32 v180, v180, v208
    v_exp_f32 v187, v187
    v_exp_f32 v180, v180
    v_cvt_pk_bf16_f32 v205, v186, v187
    v_add_f32 v181, v181, v208
    v_add_f32 v182, v182, v208
    v_exp_f32 v181, v181
    v_exp_f32 v182, v182
    v_cvt_pk_bf16_f32 v202, v180, v181
    v_add_f32 v183, v183, v208
    v_add_f32 v188, v188, v212
    v_exp_f32 v183, v183
    v_exp_f32 v188, v188
    v_cvt_pk_bf16_f32 v203, v182, v183
    v_add_f32 v189, v189, v212
    v_add_f32 v190, v190, v212
    v_exp_f32 v189, v189
    v_exp_f32 v190, v190
    v_cvt_pk_bf16_f32 v206, v188, v189
    v_add_f32 v191, v191, v212
    v_exp_f32 v191, v191
    s_nop 0
    v_cvt_pk_bf16_f32 v207, v190, v191
    s_setprio 0
    v_mfma_f32_16x16x32_bf16 v[216:219], v[224:227], v[192:195], 0
    v_mfma_f32_16x16x32_bf16 v[220:223], v[224:227], v[196:199], 0
    s_waitcnt lgkmcnt(2)
    v_mfma_f32_16x16x32_bf16 v[0:3], v[232:235], v[192:195], 0
    v_mfma_f32_16x16x32_bf16 v[32:35], v[232:235], v[196:199], 0
    ds_read_b128 v[228:231], v250 offset:4096
    v_mfma_f32_16x16x32_bf16 v[4:7], v[236:239], v[192:195], 0
    v_mfma_f32_16x16x32_bf16 v[36:39], v[236:239], v[196:199], 0
    ds_read_b128 v[232:235], v250 offset:5120
    s_waitcnt lgkmcnt(2)
    v_mfma_f32_16x16x32_bf16 v[8:11], v[240:243], v[192:195], 0
    v_mfma_f32_16x16x32_bf16 v[40:43], v[240:243], v[196:199], 0
    ds_read_b128 v[236:239], v250 offset:6144
    v_mfma_f32_16x16x32_bf16 v[12:15], v[244:247], v[192:195], 0
    v_mfma_f32_16x16x32_bf16 v[44:47], v[244:247], v[196:199], 0
    ds_read_b128 v[240:243], v250 offset:7168
    s_waitcnt lgkmcnt(2)
    v_mfma_f32_16x16x32_bf16 v[16:19], v[228:231], v[192:195], 0
    v_mfma_f32_16x16x32_bf16 v[48:51], v[228:231], v[196:199], 0
    ds_read_b128 v[244:247], v248 offset:16384
    v_mfma_f32_16x16x32_bf16 v[20:23], v[232:235], v[192:195], 0
    v_mfma_f32_16x16x32_bf16 v[52:55], v[232:235], v[196:199], 0
    ds_read_b128 v[228:231], v248 offset:17408
    s_waitcnt lgkmcnt(2)
    v_mfma_f32_16x16x32_bf16 v[24:27], v[236:239], v[192:195], 0
    v_mfma_f32_16x16x32_bf16 v[56:59], v[236:239], v[196:199], 0
    ds_read_b128 v[232:235], v248 offset:18432
    v_mfma_f32_16x16x32_bf16 v[28:31], v[240:243], v[192:195], 0
    v_mfma_f32_16x16x32_bf16 v[60:63], v[240:243], v[196:199], 0
    ds_read_b128 v[236:239], v248 offset:19456
    s_waitcnt lgkmcnt(2)
    v_mfma_f32_16x16x32_bf16 v[160:163], v[244:247], v[128:131], v[208:211]
    v_mfma_f32_16x16x32_bf16 v[168:171], v[244:247], v[144:147], v[212:215]
    ds_read_b128 v[240:243], v248 offset:20480
    v_mfma_f32_16x16x32_bf16 v[160:163], v[228:231], v[132:135], v[160:163]
    v_mfma_f32_16x16x32_bf16 v[168:171], v[228:231], v[148:151], v[168:171]
    ds_read_b128 v[244:247], v248 offset:21504
    s_waitcnt lgkmcnt(2)
    v_mfma_f32_16x16x32_bf16 v[160:163], v[232:235], v[136:139], v[160:163]
    v_mfma_f32_16x16x32_bf16 v[168:171], v[232:235], v[152:155], v[168:171]
    ds_read_b128 v[228:231], v248 offset:22528
    v_mfma_f32_16x16x32_bf16 v[160:163], v[236:239], v[140:143], v[160:163]
    v_mfma_f32_16x16x32_bf16 v[168:171], v[236:239], v[156:159], v[168:171]
    ds_read_b128 v[232:235], v248 offset:23552
    s_waitcnt lgkmcnt(2)
    v_mfma_f32_16x16x32_bf16 v[164:167], v[240:243], v[128:131], v[208:211]
    v_mfma_f32_16x16x32_bf16 v[172:175], v[240:243], v[144:147], v[212:215]
    ds_read_b128 v[236:239], v250 offset:8192
    v_mfma_f32_16x16x32_bf16 v[164:167], v[244:247], v[132:135], v[164:167]
    s_nop 0
    v_exp_f32 v160, v160
    v_mfma_f32_16x16x32_bf16 v[172:175], v[244:247], v[148:151], v[172:175]
    ds_read_b128 v[240:243], v250 offset:9216
    s_waitcnt lgkmcnt(2)
    v_mfma_f32_16x16x32_bf16 v[164:167], v[228:231], v[136:139], v[164:167]
    v_exp_f32 v161, v161
    v_mfma_f32_16x16x32_bf16 v[172:175], v[228:231], v[152:155], v[172:175]
    ds_read_b128 v[244:247], v250 offset:10240
    v_cvt_pk_bf16_f32 v192, v160, v161
    v_mfma_f32_16x16x32_bf16 v[164:167], v[232:235], v[140:143], v[164:167]
    v_exp_f32 v162, v162
    v_mfma_f32_16x16x32_bf16 v[172:175], v[232:235], v[156:159], v[172:175]
    ds_read_b128 v[228:231], v250 offset:11264
    v_mfma_f32_16x16x32_bf16 v[216:219], v[224:227], v[200:203], v[216:219]
    v_exp_f32 v163, v163
    v_mfma_f32_16x16x32_bf16 v[220:223], v[224:227], v[204:207], v[220:223]
    s_waitcnt lgkmcnt(2)
    v_mfma_f32_16x16x32_bf16 v[0:3], v[236:239], v[200:203], v[0:3]
    v_exp_f32 v168, v168
    v_mfma_f32_16x16x32_bf16 v[32:35], v[236:239], v[204:207], v[32:35]
    ds_read_b128 v[232:235], v250 offset:12288
    v_cvt_pk_bf16_f32 v193, v162, v163
    v_mfma_f32_16x16x32_bf16 v[4:7], v[240:243], v[200:203], v[4:7]
    v_exp_f32 v169, v169
    v_mfma_f32_16x16x32_bf16 v[36:39], v[240:243], v[204:207], v[36:39]
    ds_read_b128 v[236:239], v250 offset:13312
    s_waitcnt lgkmcnt(2)
    v_mfma_f32_16x16x32_bf16 v[8:11], v[244:247], v[200:203], v[8:11]
    v_exp_f32 v170, v170
    v_mfma_f32_16x16x32_bf16 v[40:43], v[244:247], v[204:207], v[40:43]
    ds_read_b128 v[240:243], v250 offset:14336
    v_cvt_pk_bf16_f32 v196, v168, v169
    v_mfma_f32_16x16x32_bf16 v[12:15], v[228:231], v[200:203], v[12:15]
    v_exp_f32 v171, v171
    v_mfma_f32_16x16x32_bf16 v[44:47], v[228:231], v[204:207], v[44:47]
    ds_read_b128 v[244:247], v250 offset:15360
    s_waitcnt lgkmcnt(2)
    v_mfma_f32_16x16x32_bf16 v[16:19], v[232:235], v[200:203], v[16:19]
    v_exp_f32 v164, v164
    v_mfma_f32_16x16x32_bf16 v[48:51], v[232:235], v[204:207], v[48:51]
    ds_read_b128 v[228:231], v248 offset:24576
    v_cvt_pk_bf16_f32 v197, v170, v171
    v_mfma_f32_16x16x32_bf16 v[20:23], v[236:239], v[200:203], v[20:23]
    v_exp_f32 v165, v165
    v_mfma_f32_16x16x32_bf16 v[52:55], v[236:239], v[204:207], v[52:55]
    ds_read_b128 v[232:235], v248 offset:25600
    s_waitcnt lgkmcnt(2)
    v_mfma_f32_16x16x32_bf16 v[24:27], v[240:243], v[200:203], v[24:27]
    v_exp_f32 v166, v166
    v_mfma_f32_16x16x32_bf16 v[56:59], v[240:243], v[204:207], v[56:59]
    ds_read_b128 v[236:239], v248 offset:26624
    v_cvt_pk_bf16_f32 v194, v164, v165
    v_mfma_f32_16x16x32_bf16 v[28:31], v[244:247], v[200:203], v[28:31]
    v_exp_f32 v167, v167
    v_mfma_f32_16x16x32_bf16 v[60:63], v[244:247], v[204:207], v[60:63]
    ds_read_b128 v[240:243], v248 offset:27648
    s_waitcnt lgkmcnt(2)
    v_mfma_f32_16x16x32_bf16 v[176:179], v[228:231], v[128:131], v[208:211]
    v_exp_f32 v172, v172
    v_mfma_f32_16x16x32_bf16 v[184:187], v[228:231], v[144:147], v[212:215]
    ds_read_b128 v[244:247], v248 offset:28672
    v_cvt_pk_bf16_f32 v195, v166, v167
    v_mfma_f32_16x16x32_bf16 v[176:179], v[232:235], v[132:135], v[176:179]
    v_exp_f32 v173, v173
    v_mfma_f32_16x16x32_bf16 v[184:187], v[232:235], v[148:151], v[184:187]
    ds_read_b128 v[228:231], v248 offset:29696
    s_waitcnt lgkmcnt(2)
    v_mfma_f32_16x16x32_bf16 v[176:179], v[236:239], v[136:139], v[176:179]
    v_exp_f32 v174, v174
    v_mfma_f32_16x16x32_bf16 v[184:187], v[236:239], v[152:155], v[184:187]
    ds_read_b128 v[232:235], v248 offset:30720
    v_cvt_pk_bf16_f32 v198, v172, v173
    v_mfma_f32_16x16x32_bf16 v[176:179], v[240:243], v[140:143], v[176:179]
    v_exp_f32 v175, v175
    v_mfma_f32_16x16x32_bf16 v[184:187], v[240:243], v[156:159], v[184:187]
    ds_read_b128 v[236:239], v248 offset:31744
    s_waitcnt lgkmcnt(2)
    v_mfma_f32_16x16x32_bf16 v[180:183], v[244:247], v[128:131], v[208:211]
    v_cvt_pk_bf16_f32 v199, v174, v175
    v_mfma_f32_16x16x32_bf16 v[188:191], v[244:247], v[144:147], v[212:215]
    ds_read_b128 v[240:243], v250 offset:16384
    v_mfma_f32_16x16x32_bf16 v[180:183], v[228:231], v[132:135], v[180:183]
    v_exp_f32 v176, v176
    v_mfma_f32_16x16x32_bf16 v[188:191], v[228:231], v[148:151], v[188:191]
    ds_read_b128 v[244:247], v250 offset:17408
    s_waitcnt lgkmcnt(2)
    v_mfma_f32_16x16x32_bf16 v[180:183], v[232:235], v[136:139], v[180:183]
    v_exp_f32 v177, v177
    v_mfma_f32_16x16x32_bf16 v[188:191], v[232:235], v[152:155], v[188:191]
    ds_read_b128 v[228:231], v250 offset:18432
    v_cvt_pk_bf16_f32 v200, v176, v177
    v_mfma_f32_16x16x32_bf16 v[180:183], v[236:239], v[140:143], v[180:183]
    v_exp_f32 v178, v178
    v_mfma_f32_16x16x32_bf16 v[188:191], v[236:239], v[156:159], v[188:191]
    ds_read_b128 v[232:235], v250 offset:19456
    v_mfma_f32_16x16x32_bf16 v[216:219], v[224:227], v[192:195], v[216:219]
    v_exp_f32 v179, v179
    v_mfma_f32_16x16x32_bf16 v[220:223], v[224:227], v[196:199], v[220:223]
    s_waitcnt lgkmcnt(2)
    v_mfma_f32_16x16x32_bf16 v[0:3], v[240:243], v[192:195], v[0:3]
    v_exp_f32 v184, v184
    v_cvt_pk_bf16_f32 v201, v178, v179
    v_mfma_f32_16x16x32_bf16 v[32:35], v[240:243], v[196:199], v[32:35]
    ds_read_b128 v[236:239], v250 offset:20480
    v_exp_f32 v185, v185
    v_mfma_f32_16x16x32_bf16 v[4:7], v[244:247], v[192:195], v[4:7]
    v_exp_f32 v186, v186
    v_mfma_f32_16x16x32_bf16 v[36:39], v[244:247], v[196:199], v[36:39]
    ds_read_b128 v[240:243], v250 offset:21504
    s_waitcnt lgkmcnt(2)
    v_mfma_f32_16x16x32_bf16 v[8:11], v[228:231], v[192:195], v[8:11]
    v_exp_f32 v187, v187
    v_mfma_f32_16x16x32_bf16 v[40:43], v[228:231], v[196:199], v[40:43]
    ds_read_b128 v[244:247], v250 offset:22528
    v_cvt_pk_bf16_f32 v204, v184, v185
    v_mfma_f32_16x16x32_bf16 v[12:15], v[232:235], v[192:195], v[12:15]
    v_exp_f32 v180, v180
    v_mfma_f32_16x16x32_bf16 v[44:47], v[232:235], v[196:199], v[44:47]
    ds_read_b128 v[228:231], v250 offset:23552
    s_waitcnt lgkmcnt(2)
    v_mfma_f32_16x16x32_bf16 v[16:19], v[236:239], v[192:195], v[16:19]
    v_exp_f32 v181, v181
    v_mfma_f32_16x16x32_bf16 v[48:51], v[236:239], v[196:199], v[48:51]
    ds_read_b128 v[232:235], v248 offset:32768
    v_cvt_pk_bf16_f32 v205, v186, v187
    v_mfma_f32_16x16x32_bf16 v[20:23], v[240:243], v[192:195], v[20:23]
    v_exp_f32 v182, v182
    v_mfma_f32_16x16x32_bf16 v[52:55], v[240:243], v[196:199], v[52:55]
    ds_read_b128 v[236:239], v248 offset:33792
    s_waitcnt lgkmcnt(2)
    v_mfma_f32_16x16x32_bf16 v[24:27], v[244:247], v[192:195], v[24:27]
    v_exp_f32 v183, v183
    v_mfma_f32_16x16x32_bf16 v[56:59], v[244:247], v[196:199], v[56:59]
    ds_read_b128 v[240:243], v248 offset:34816
    v_cvt_pk_bf16_f32 v202, v180, v181
    v_mfma_f32_16x16x32_bf16 v[28:31], v[228:231], v[192:195], v[28:31]
    v_exp_f32 v188, v188
    v_mfma_f32_16x16x32_bf16 v[60:63], v[228:231], v[196:199], v[60:63]
    ds_read_b128 v[244:247], v248 offset:35840
    s_waitcnt lgkmcnt(2)
    v_mfma_f32_16x16x32_bf16 v[160:163], v[232:235], v[128:131], v[208:211]
    v_exp_f32 v189, v189
    v_cvt_pk_bf16_f32 v203, v182, v183
    v_mfma_f32_16x16x32_bf16 v[168:171], v[232:235], v[144:147], v[212:215]
    ds_read_b128 v[228:231], v248 offset:36864
    v_cvt_pk_bf16_f32 v206, v188, v189
    v_mfma_f32_16x16x32_bf16 v[160:163], v[236:239], v[132:135], v[160:163]
    v_exp_f32 v190, v190
    v_mfma_f32_16x16x32_bf16 v[168:171], v[236:239], v[148:151], v[168:171]
    ds_read_b128 v[232:235], v248 offset:37888
    s_waitcnt lgkmcnt(2)
    v_mfma_f32_16x16x32_bf16 v[160:163], v[240:243], v[136:139], v[160:163]
    v_exp_f32 v191, v191
    v_mfma_f32_16x16x32_bf16 v[168:171], v[240:243], v[152:155], v[168:171]
    ds_read_b128 v[236:239], v248 offset:38912
    v_cvt_pk_bf16_f32 v207, v190, v191
    v_mfma_f32_16x16x32_bf16 v[160:163], v[244:247], v[140:143], v[160:163]
    v_mfma_f32_16x16x32_bf16 v[168:171], v[244:247], v[156:159], v[168:171]
    ds_read_b128 v[240:243], v248 offset:39936
    s_waitcnt lgkmcnt(2)
    v_mfma_f32_16x16x32_bf16 v[164:167], v[228:231], v[128:131], v[208:211]
    v_mfma_f32_16x16x32_bf16 v[172:175], v[228:231], v[144:147], v[212:215]
    ds_read_b128 v[244:247], v250 offset:24576
    v_mfma_f32_16x16x32_bf16 v[164:167], v[232:235], v[132:135], v[164:167]
    s_nop 0
    v_exp_f32 v160, v160
    v_mfma_f32_16x16x32_bf16 v[172:175], v[232:235], v[148:151], v[172:175]
    ds_read_b128 v[228:231], v250 offset:25600
    s_waitcnt lgkmcnt(2)
    v_mfma_f32_16x16x32_bf16 v[164:167], v[236:239], v[136:139], v[164:167]
    v_exp_f32 v161, v161
    v_mfma_f32_16x16x32_bf16 v[172:175], v[236:239], v[152:155], v[172:175]
    ds_read_b128 v[232:235], v250 offset:26624
    v_cvt_pk_bf16_f32 v64, v160, v161
    v_mfma_f32_16x16x32_bf16 v[164:167], v[240:243], v[140:143], v[164:167]
    v_exp_f32 v162, v162
    v_mfma_f32_16x16x32_bf16 v[172:175], v[240:243], v[156:159], v[172:175]
    ds_read_b128 v[236:239], v250 offset:27648
    v_mfma_f32_16x16x32_bf16 v[216:219], v[224:227], v[200:203], v[216:219]
    v_exp_f32 v163, v163
    v_mfma_f32_16x16x32_bf16 v[220:223], v[224:227], v[204:207], v[220:223]
    s_waitcnt lgkmcnt(2)
    v_mfma_f32_16x16x32_bf16 v[0:3], v[244:247], v[200:203], v[0:3]
    v_exp_f32 v168, v168
    v_cvt_pk_bf16_f32 v65, v162, v163
    v_mfma_f32_16x16x32_bf16 v[32:35], v[244:247], v[204:207], v[32:35]
    ds_read_b128 v[240:243], v250 offset:28672
    v_exp_f32 v169, v169
    v_mfma_f32_16x16x32_bf16 v[4:7], v[228:231], v[200:203], v[4:7]
    v_exp_f32 v170, v170
    v_cvt_pk_bf16_f32 v68, v168, v169
    v_mfma_f32_16x16x32_bf16 v[36:39], v[228:231], v[204:207], v[36:39]
    ds_read_b128 v[244:247], v250 offset:29696
    s_waitcnt lgkmcnt(2)
    v_mfma_f32_16x16x32_bf16 v[8:11], v[232:235], v[200:203], v[8:11]
    v_exp_f32 v171, v171
    v_mfma_f32_16x16x32_bf16 v[40:43], v[232:235], v[204:207], v[40:43]
    ds_read_b128 v[228:231], v250 offset:30720
    v_cvt_pk_bf16_f32 v69, v170, v171
    v_mfma_f32_16x16x32_bf16 v[12:15], v[236:239], v[200:203], v[12:15]
    v_exp_f32 v164, v164
    v_mfma_f32_16x16x32_bf16 v[44:47], v[236:239], v[204:207], v[44:47]
    ds_read_b128 v[232:235], v250 offset:31744
    s_waitcnt lgkmcnt(2)
    v_mfma_f32_16x16x32_bf16 v[16:19], v[240:243], v[200:203], v[16:19]
    v_exp_f32 v165, v165
    v_mfma_f32_16x16x32_bf16 v[48:51], v[240:243], v[204:207], v[48:51]
    ds_read_b128 v[236:239], v248 offset:40960
    v_cvt_pk_bf16_f32 v66, v164, v165
    v_mfma_f32_16x16x32_bf16 v[20:23], v[244:247], v[200:203], v[20:23]
    v_exp_f32 v166, v166
    v_mfma_f32_16x16x32_bf16 v[52:55], v[244:247], v[204:207], v[52:55]
    ds_read_b128 v[240:243], v248 offset:41984
    s_waitcnt lgkmcnt(2)
    v_mfma_f32_16x16x32_bf16 v[24:27], v[228:231], v[200:203], v[24:27]
    v_exp_f32 v167, v167
    v_mfma_f32_16x16x32_bf16 v[56:59], v[228:231], v[204:207], v[56:59]
    ds_read_b128 v[244:247], v248 offset:43008
    v_cvt_pk_bf16_f32 v67, v166, v167
    v_mfma_f32_16x16x32_bf16 v[28:31], v[232:235], v[200:203], v[28:31]
    v_exp_f32 v172, v172
    v_mfma_f32_16x16x32_bf16 v[60:63], v[232:235], v[204:207], v[60:63]
    ds_read_b128 v[228:231], v248 offset:44032
    s_waitcnt lgkmcnt(2)
    v_mfma_f32_16x16x32_bf16 v[176:179], v[236:239], v[128:131], v[208:211]
    v_exp_f32 v173, v173
    v_mfma_f32_16x16x32_bf16 v[184:187], v[236:239], v[144:147], v[212:215]
    ds_read_b128 v[232:235], v248 offset:45056
    v_cvt_pk_bf16_f32 v70, v172, v173
    v_mfma_f32_16x16x32_bf16 v[176:179], v[240:243], v[132:135], v[176:179]
    v_exp_f32 v174, v174
    v_mfma_f32_16x16x32_bf16 v[184:187], v[240:243], v[148:151], v[184:187]
    ds_read_b128 v[236:239], v248 offset:46080
    s_waitcnt lgkmcnt(2)
    v_mfma_f32_16x16x32_bf16 v[176:179], v[244:247], v[136:139], v[176:179]
    v_exp_f32 v175, v175
    v_mfma_f32_16x16x32_bf16 v[184:187], v[244:247], v[152:155], v[184:187]
    ds_read_b128 v[240:243], v248 offset:47104
    v_cvt_pk_bf16_f32 v71, v174, v175
    v_mfma_f32_16x16x32_bf16 v[176:179], v[228:231], v[140:143], v[176:179]
    v_mfma_f32_16x16x32_bf16 v[184:187], v[228:231], v[156:159], v[184:187]
    ds_read_b128 v[244:247], v248 offset:48128
    s_waitcnt lgkmcnt(2)
    v_mfma_f32_16x16x32_bf16 v[180:183], v[232:235], v[128:131], v[208:211]
    v_mfma_f32_16x16x32_bf16 v[188:191], v[232:235], v[144:147], v[212:215]
    ds_read_b128 v[228:231], v250 offset:32768
    v_mfma_f32_16x16x32_bf16 v[180:183], v[236:239], v[132:135], v[180:183]
    s_nop 0
    v_exp_f32 v176, v176
    v_mfma_f32_16x16x32_bf16 v[188:191], v[236:239], v[148:151], v[188:191]
    ds_read_b128 v[232:235], v250 offset:33792
    s_waitcnt lgkmcnt(2)
    v_mfma_f32_16x16x32_bf16 v[180:183], v[240:243], v[136:139], v[180:183]
    v_exp_f32 v177, v177
    v_mfma_f32_16x16x32_bf16 v[188:191], v[240:243], v[152:155], v[188:191]
    ds_read_b128 v[236:239], v248 offset:49152
    v_cvt_pk_bf16_f32 v72, v176, v177
    v_mfma_f32_16x16x32_bf16 v[180:183], v[244:247], v[140:143], v[180:183]
    v_exp_f32 v178, v178
    v_mfma_f32_16x16x32_bf16 v[188:191], v[244:247], v[156:159], v[188:191]
    ds_read_b128 v[240:243], v248 offset:50176
    v_mfma_f32_16x16x32_bf16 v[216:219], v[224:227], v[64:67], v[216:219]
    v_exp_f32 v179, v179
    v_mfma_f32_16x16x32_bf16 v[220:223], v[224:227], v[68:71], v[220:223]
    s_waitcnt lgkmcnt(2)
    v_mfma_f32_16x16x32_bf16 v[0:3], v[228:231], v[64:67], v[0:3]
    v_exp_f32 v184, v184
    v_cvt_pk_bf16_f32 v73, v178, v179
    v_mfma_f32_16x16x32_bf16 v[32:35], v[228:231], v[68:71], v[32:35]
    ds_read_b128 v[244:247], v248 offset:51200
    v_exp_f32 v185, v185
    v_mfma_f32_16x16x32_bf16 v[4:7], v[232:235], v[64:67], v[4:7]
    v_exp_f32 v186, v186
    v_cvt_pk_bf16_f32 v76, v184, v185
    v_mfma_f32_16x16x32_bf16 v[36:39], v[232:235], v[68:71], v[36:39]
    ds_read_b128 v[228:231], v248 offset:52224
    s_waitcnt lgkmcnt(2)
    v_mfma_f32_16x16x32_bf16 v[160:163], v[236:239], v[128:131], v[208:211]
    v_exp_f32 v187, v187
    v_mfma_f32_16x16x32_bf16 v[168:171], v[236:239], v[144:147], v[212:215]
    ds_read_b128 v[232:235], v248 offset:53248
    v_cvt_pk_bf16_f32 v77, v186, v187
    v_mfma_f32_16x16x32_bf16 v[160:163], v[240:243], v[132:135], v[160:163]
    v_exp_f32 v180, v180
    v_mfma_f32_16x16x32_bf16 v[168:171], v[240:243], v[148:151], v[168:171]
    ds_read_b128 v[236:239], v248 offset:54272
    s_waitcnt lgkmcnt(2)
    v_mfma_f32_16x16x32_bf16 v[160:163], v[244:247], v[136:139], v[160:163]
    v_exp_f32 v181, v181
    v_mfma_f32_16x16x32_bf16 v[168:171], v[244:247], v[152:155], v[168:171]
    ds_read_b128 v[240:243], v248 offset:55296
    v_cvt_pk_bf16_f32 v74, v180, v181
    v_mfma_f32_16x16x32_bf16 v[160:163], v[228:231], v[140:143], v[160:163]
    v_exp_f32 v182, v182
    v_mfma_f32_16x16x32_bf16 v[168:171], v[228:231], v[156:159], v[168:171]
    ds_read_b128 v[244:247], v248 offset:56320
    s_waitcnt lgkmcnt(2)
    v_mfma_f32_16x16x32_bf16 v[164:167], v[232:235], v[128:131], v[208:211]
    v_exp_f32 v183, v183
    v_mfma_f32_16x16x32_bf16 v[172:175], v[232:235], v[144:147], v[212:215]
    ds_read_b128 v[228:231], v250 offset:40960
    v_cvt_pk_bf16_f32 v75, v182, v183
    v_mfma_f32_16x16x32_bf16 v[164:167], v[236:239], v[132:135], v[164:167]
    v_exp_f32 v188, v188
    v_mfma_f32_16x16x32_bf16 v[172:175], v[236:239], v[148:151], v[172:175]
    ds_read_b128 v[232:235], v250 offset:41984
    s_waitcnt lgkmcnt(2)
    v_mfma_f32_16x16x32_bf16 v[164:167], v[240:243], v[136:139], v[164:167]
    v_exp_f32 v189, v189
    v_mfma_f32_16x16x32_bf16 v[172:175], v[240:243], v[152:155], v[172:175]
    ds_read_b128 v[236:239], v248 offset:57344
    v_cvt_pk_bf16_f32 v78, v188, v189
    v_exp_f32 v190, v190
    v_mfma_f32_16x16x32_bf16 v[164:167], v[244:247], v[140:143], v[164:167]
    v_exp_f32 v191, v191
    v_mfma_f32_16x16x32_bf16 v[172:175], v[244:247], v[156:159], v[172:175]
    ds_read_b128 v[240:243], v248 offset:58368
    v_cvt_pk_bf16_f32 v79, v190, v191
    v_mfma_f32_16x16x32_bf16 v[216:219], v[224:227], v[72:75], v[216:219]
    v_exp_f32 v160, v160
    v_mfma_f32_16x16x32_bf16 v[220:223], v[224:227], v[76:79], v[220:223]
    s_waitcnt lgkmcnt(2)
    v_mfma_f32_16x16x32_bf16 v[0:3], v[228:231], v[72:75], v[0:3]
    v_exp_f32 v161, v161
    v_mfma_f32_16x16x32_bf16 v[32:35], v[228:231], v[76:79], v[32:35]
    ds_read_b128 v[244:247], v248 offset:59392
    v_cvt_pk_bf16_f32 v192, v160, v161
    v_mfma_f32_16x16x32_bf16 v[4:7], v[232:235], v[72:75], v[4:7]
    v_exp_f32 v162, v162
    v_mfma_f32_16x16x32_bf16 v[36:39], v[232:235], v[76:79], v[36:39]
    ds_read_b128 v[228:231], v248 offset:60416
    s_waitcnt lgkmcnt(2)
    v_mfma_f32_16x16x32_bf16 v[176:179], v[236:239], v[128:131], v[208:211]
    v_exp_f32 v163, v163
    v_mfma_f32_16x16x32_bf16 v[184:187], v[236:239], v[144:147], v[212:215]
    ds_read_b128 v[232:235], v248 offset:61440
    v_cvt_pk_bf16_f32 v193, v162, v163
    v_mfma_f32_16x16x32_bf16 v[176:179], v[240:243], v[132:135], v[176:179]
    v_exp_f32 v168, v168
    v_mfma_f32_16x16x32_bf16 v[184:187], v[240:243], v[148:151], v[184:187]
    ds_read_b128 v[236:239], v248 offset:62464
    v_exp_f32 v169, v169
    s_waitcnt lgkmcnt(2)
    v_mfma_f32_16x16x32_bf16 v[176:179], v[244:247], v[136:139], v[176:179]
    v_exp_f32 v170, v170
    v_cvt_pk_bf16_f32 v196, v168, v169
    v_mfma_f32_16x16x32_bf16 v[184:187], v[244:247], v[152:155], v[184:187]
    ds_read_b128 v[240:243], v248 offset:63488
    v_exp_f32 v171, v171
    v_mfma_f32_16x16x32_bf16 v[176:179], v[228:231], v[140:143], v[176:179]
    v_exp_f32 v164, v164
    v_cvt_pk_bf16_f32 v197, v170, v171
    v_mfma_f32_16x16x32_bf16 v[184:187], v[228:231], v[156:159], v[184:187]
    ds_read_b128 v[244:247], v248 offset:64512
    s_waitcnt lgkmcnt(2)
    v_mfma_f32_16x16x32_bf16 v[180:183], v[232:235], v[128:131], v[208:211]
    v_exp_f32 v165, v165
    v_exp_f32 v166, v166
    v_mfma_f32_16x16x32_bf16 v[188:191], v[232:235], v[144:147], v[212:215]
    ds_read_b128 v[228:231], v250 offset:49152
    v_cvt_pk_bf16_f32 v194, v164, v165
    v_mfma_f32_16x16x32_bf16 v[180:183], v[236:239], v[132:135], v[180:183]
    v_exp_f32 v167, v167
    v_exp_f32 v172, v172
    v_mfma_f32_16x16x32_bf16 v[188:191], v[236:239], v[148:151], v[188:191]
    ds_read_b128 v[232:235], v250 offset:50176
    v_cvt_pk_bf16_f32 v195, v166, v167
    s_waitcnt lgkmcnt(2)
    v_mfma_f32_16x16x32_bf16 v[180:183], v[240:243], v[136:139], v[180:183]
    v_exp_f32 v173, v173
    v_mfma_f32_16x16x32_bf16 v[188:191], v[240:243], v[152:155], v[188:191]
    ds_read_b128 v[236:239], v249 offset:0
    v_cvt_pk_bf16_f32 v198, v172, v173
    v_exp_f32 v174, v174
    v_mfma_f32_16x16x32_bf16 v[180:183], v[244:247], v[140:143], v[180:183]
    v_exp_f32 v175, v175
    v_mfma_f32_16x16x32_bf16 v[188:191], v[244:247], v[156:159], v[188:191]
    ds_read_b128 v[240:243], v249 offset:1024
    v_cvt_pk_bf16_f32 v199, v174, v175
    v_mfma_f32_16x16x32_bf16 v[216:219], v[224:227], v[192:195], v[216:219]
    v_exp_f32 v176, v176
    v_mfma_f32_16x16x32_bf16 v[220:223], v[224:227], v[196:199], v[220:223]
    s_waitcnt lgkmcnt(2)
    v_mfma_f32_16x16x32_bf16 v[0:3], v[228:231], v[192:195], v[0:3]
    v_exp_f32 v177, v177
    v_mfma_f32_16x16x32_bf16 v[32:35], v[228:231], v[196:199], v[32:35]
    ds_read_b128 v[244:247], v249 offset:2048
    v_cvt_pk_bf16_f32 v200, v176, v177
    v_mfma_f32_16x16x32_bf16 v[4:7], v[232:235], v[192:195], v[4:7]
    v_exp_f32 v178, v178
    v_mfma_f32_16x16x32_bf16 v[36:39], v[232:235], v[196:199], v[36:39]
    ds_read_b128 v[228:231], v249 offset:3072
    s_waitcnt lgkmcnt(2)
    v_mfma_f32_16x16x32_bf16 v[160:163], v[236:239], v[128:131], v[208:211]
    v_exp_f32 v179, v179
    v_mfma_f32_16x16x32_bf16 v[168:171], v[236:239], v[144:147], v[212:215]
    ds_read_b128 v[232:235], v249 offset:4096
    v_cvt_pk_bf16_f32 v201, v178, v179
    v_mfma_f32_16x16x32_bf16 v[160:163], v[240:243], v[132:135], v[160:163]
    v_exp_f32 v184, v184
    v_mfma_f32_16x16x32_bf16 v[168:171], v[240:243], v[148:151], v[168:171]
    ds_read_b128 v[236:239], v249 offset:5120
    v_exp_f32 v185, v185
    s_waitcnt lgkmcnt(2)
    v_mfma_f32_16x16x32_bf16 v[160:163], v[244:247], v[136:139], v[160:163]
    v_exp_f32 v186, v186
    v_cvt_pk_bf16_f32 v204, v184, v185
    v_mfma_f32_16x16x32_bf16 v[168:171], v[244:247], v[152:155], v[168:171]
    ds_read_b128 v[240:243], v249 offset:6144
    v_exp_f32 v187, v187
    v_mfma_f32_16x16x32_bf16 v[160:163], v[228:231], v[140:143], v[160:163]
    v_exp_f32 v180, v180
    v_cvt_pk_bf16_f32 v205, v186, v187
    v_mfma_f32_16x16x32_bf16 v[168:171], v[228:231], v[156:159], v[168:171]
    ds_read_b128 v[244:247], v249 offset:7168
    s_waitcnt lgkmcnt(2)
    v_mfma_f32_16x16x32_bf16 v[164:167], v[232:235], v[128:131], v[208:211]
    v_exp_f32 v181, v181
    v_exp_f32 v182, v182
    v_mfma_f32_16x16x32_bf16 v[172:175], v[232:235], v[144:147], v[212:215]
    ds_read_b128 v[228:231], v250 offset:57344
    v_cvt_pk_bf16_f32 v202, v180, v181
    v_mfma_f32_16x16x32_bf16 v[164:167], v[236:239], v[132:135], v[164:167]
    v_exp_f32 v183, v183
    v_exp_f32 v188, v188
    v_mfma_f32_16x16x32_bf16 v[172:175], v[236:239], v[148:151], v[172:175]
    ds_read_b128 v[232:235], v250 offset:58368
    v_cvt_pk_bf16_f32 v203, v182, v183
    s_waitcnt lgkmcnt(2)
    v_mfma_f32_16x16x32_bf16 v[164:167], v[240:243], v[136:139], v[164:167]
    v_exp_f32 v189, v189
    v_mfma_f32_16x16x32_bf16 v[172:175], v[240:243], v[152:155], v[172:175]
    ds_read_b128 v[236:239], v249 offset:8192
    v_cvt_pk_bf16_f32 v206, v188, v189
    v_exp_f32 v190, v190
    v_mfma_f32_16x16x32_bf16 v[164:167], v[244:247], v[140:143], v[164:167]
    v_exp_f32 v191, v191
    v_mfma_f32_16x16x32_bf16 v[172:175], v[244:247], v[156:159], v[172:175]
    ds_read_b128 v[240:243], v249 offset:9216
    v_cvt_pk_bf16_f32 v207, v190, v191
    v_mfma_f32_16x16x32_bf16 v[216:219], v[224:227], v[200:203], v[216:219]
    v_exp_f32 v160, v160
    v_mfma_f32_16x16x32_bf16 v[220:223], v[224:227], v[204:207], v[220:223]
    s_waitcnt lgkmcnt(2)
    v_mfma_f32_16x16x32_bf16 v[0:3], v[228:231], v[200:203], v[0:3]
    v_exp_f32 v161, v161
    v_mfma_f32_16x16x32_bf16 v[32:35], v[228:231], v[204:207], v[32:35]
    ds_read_b128 v[244:247], v249 offset:10240
    v_cvt_pk_bf16_f32 v80, v160, v161
    v_mfma_f32_16x16x32_bf16 v[4:7], v[232:235], v[200:203], v[4:7]
    v_exp_f32 v162, v162
    v_mfma_f32_16x16x32_bf16 v[36:39], v[232:235], v[204:207], v[36:39]
    ds_read_b128 v[228:231], v249 offset:11264
    s_waitcnt lgkmcnt(2)
    v_mfma_f32_16x16x32_bf16 v[176:179], v[236:239], v[128:131], v[208:211]
    v_exp_f32 v163, v163
    v_mfma_f32_16x16x32_bf16 v[184:187], v[236:239], v[144:147], v[212:215]
    ds_read_b128 v[232:235], v249 offset:12288
    v_cvt_pk_bf16_f32 v81, v162, v163
    v_exp_f32 v168, v168
    v_mfma_f32_16x16x32_bf16 v[176:179], v[240:243], v[132:135], v[176:179]
    v_exp_f32 v169, v169
    v_mfma_f32_16x16x32_bf16 v[184:187], v[240:243], v[148:151], v[184:187]
    ds_read_b128 v[236:239], v249 offset:13312
    v_cvt_pk_bf16_f32 v84, v168, v169
    s_waitcnt lgkmcnt(2)
    v_mfma_f32_16x16x32_bf16 v[176:179], v[244:247], v[136:139], v[176:179]
    v_exp_f32 v170, v170
    v_exp_f32 v171, v171
    v_mfma_f32_16x16x32_bf16 v[184:187], v[244:247], v[152:155], v[184:187]
    ds_read_b128 v[240:243], v249 offset:14336
    v_cvt_pk_bf16_f32 v85, v170, v171
    v_mfma_f32_16x16x32_bf16 v[176:179], v[228:231], v[140:143], v[176:179]
    v_exp_f32 v164, v164
    v_exp_f32 v165, v165
    v_mfma_f32_16x16x32_bf16 v[184:187], v[228:231], v[156:159], v[184:187]
    ds_read_b128 v[244:247], v249 offset:15360
    v_cvt_pk_bf16_f32 v82, v164, v165
    s_waitcnt lgkmcnt(2)
    v_mfma_f32_16x16x32_bf16 v[180:183], v[232:235], v[128:131], v[208:211]
    v_exp_f32 v166, v166
    v_mfma_f32_16x16x32_bf16 v[188:191], v[232:235], v[144:147], v[212:215]
    ds_read_b128 v[228:231], v251 offset:0
    v_exp_f32 v167, v167
    v_mfma_f32_16x16x32_bf16 v[180:183], v[236:239], v[132:135], v[180:183]
    v_exp_f32 v172, v172
    v_cvt_pk_bf16_f32 v83, v166, v167
    v_mfma_f32_16x16x32_bf16 v[188:191], v[236:239], v[148:151], v[188:191]
    ds_read_b128 v[232:235], v251 offset:1024
    v_exp_f32 v173, v173
    s_waitcnt lgkmcnt(2)
    v_mfma_f32_16x16x32_bf16 v[180:183], v[240:243], v[136:139], v[180:183]
    v_exp_f32 v174, v174
    v_cvt_pk_bf16_f32 v86, v172, v173
    v_mfma_f32_16x16x32_bf16 v[188:191], v[240:243], v[152:155], v[188:191]
    ds_read_b128 v[236:239], v250 offset:34816
    v_exp_f32 v175, v175
    v_mfma_f32_16x16x32_bf16 v[180:183], v[244:247], v[140:143], v[180:183]
    v_exp_f32 v176, v176
    v_cvt_pk_bf16_f32 v87, v174, v175
    v_mfma_f32_16x16x32_bf16 v[188:191], v[244:247], v[156:159], v[188:191]
    ds_read_b128 v[240:243], v250 offset:35840
    v_mfma_f32_16x16x32_bf16 v[216:219], v[224:227], v[80:83], v[216:219]
    v_exp_f32 v177, v177
    v_mfma_f32_16x16x32_bf16 v[220:223], v[224:227], v[84:87], v[220:223]
    s_waitcnt lgkmcnt(2)
    v_mfma_f32_16x16x32_bf16 v[0:3], v[228:231], v[80:83], v[0:3]
    v_exp_f32 v178, v178
    v_cvt_pk_bf16_f32 v88, v176, v177
    v_mfma_f32_16x16x32_bf16 v[32:35], v[228:231], v[84:87], v[32:35]
    ds_read_b128 v[244:247], v250 offset:43008
    v_exp_f32 v179, v179
    v_mfma_f32_16x16x32_bf16 v[4:7], v[232:235], v[80:83], v[4:7]
    v_exp_f32 v184, v184
    v_cvt_pk_bf16_f32 v89, v178, v179
    v_mfma_f32_16x16x32_bf16 v[36:39], v[232:235], v[84:87], v[36:39]
    ds_read_b128 v[228:231], v250 offset:44032
    v_exp_f32 v185, v185
    s_waitcnt lgkmcnt(2)
    v_mfma_f32_16x16x32_bf16 v[8:11], v[236:239], v[64:67], v[8:11]
    v_exp_f32 v186, v186
    v_cvt_pk_bf16_f32 v92, v184, v185
    v_mfma_f32_16x16x32_bf16 v[40:43], v[236:239], v[68:71], v[40:43]
    ds_read_b128 v[232:235], v250 offset:51200
    v_exp_f32 v187, v187
    v_mfma_f32_16x16x32_bf16 v[12:15], v[240:243], v[64:67], v[12:15]
    v_exp_f32 v180, v180
    v_cvt_pk_bf16_f32 v93, v186, v187
    v_mfma_f32_16x16x32_bf16 v[44:47], v[240:243], v[68:71], v[44:47]
    ds_read_b128 v[236:239], v250 offset:52224
    s_waitcnt lgkmcnt(2)
    v_mfma_f32_16x16x32_bf16 v[8:11], v[244:247], v[72:75], v[8:11]
    v_exp_f32 v181, v181
    v_exp_f32 v182, v182
    v_mfma_f32_16x16x32_bf16 v[40:43], v[244:247], v[76:79], v[40:43]
    ds_read_b128 v[240:243], v251 offset:8192
    v_cvt_pk_bf16_f32 v90, v180, v181
    v_mfma_f32_16x16x32_bf16 v[12:15], v[228:231], v[72:75], v[12:15]
    v_exp_f32 v183, v183
    v_exp_f32 v188, v188
    v_mfma_f32_16x16x32_bf16 v[44:47], v[228:231], v[76:79], v[44:47]
    ds_read_b128 v[244:247], v251 offset:9216
    v_cvt_pk_bf16_f32 v91, v182, v183
    s_waitcnt lgkmcnt(2)
    v_mfma_f32_16x16x32_bf16 v[8:11], v[232:235], v[192:195], v[8:11]
    v_exp_f32 v189, v189
    v_mfma_f32_16x16x32_bf16 v[40:43], v[232:235], v[196:199], v[40:43]
    ds_read_b128 v[228:231], v250 offset:59392
    v_cvt_pk_bf16_f32 v94, v188, v189
    v_exp_f32 v190, v190
    v_mfma_f32_16x16x32_bf16 v[12:15], v[236:239], v[192:195], v[12:15]
    v_exp_f32 v191, v191
    v_mfma_f32_16x16x32_bf16 v[44:47], v[236:239], v[196:199], v[44:47]
    ds_read_b128 v[232:235], v250 offset:60416
    v_cvt_pk_bf16_f32 v95, v190, v191
    v_mfma_f32_16x16x32_bf16 v[216:219], v[224:227], v[88:91], v[216:219]
    s_nop 0
    v_mfma_f32_16x16x32_bf16 v[220:223], v[224:227], v[92:95], v[220:223]
    s_waitcnt lgkmcnt(2)
    v_mfma_f32_16x16x32_bf16 v[0:3], v[240:243], v[88:91], v[0:3]
    v_mfma_f32_16x16x32_bf16 v[32:35], v[240:243], v[92:95], v[32:35]
    ds_read_b128 v[236:239], v251 offset:2048
    v_mfma_f32_16x16x32_bf16 v[4:7], v[244:247], v[88:91], v[4:7]
    v_mfma_f32_16x16x32_bf16 v[36:39], v[244:247], v[92:95], v[36:39]
    ds_read_b128 v[240:243], v251 offset:3072
    v_cmp_gt_f32 vcc, s29, v216
    v_cmp_gt_f32 s[38:39], s29, v220
    s_nop 0
    s_and_b64 vcc, vcc, s[38:39]
    s_cmp_eq_u64 vcc, -1
    s_cbranch_scc0 L_fix2
    s_waitcnt lgkmcnt(2)
    v_mfma_f32_16x16x32_bf16 v[8:11], v[228:231], v[200:203], v[8:11]
    v_rcp_f32 v253, v216
    v_rcp_f32 v254, v220
    v_mfma_f32_16x16x32_bf16 v[40:43], v[228:231], v[204:207], v[40:43]
    ds_read_b128 v[244:247], v251 offset:10240
    v_mfma_f32_16x16x32_bf16 v[12:15], v[232:235], v[200:203], v[12:15]
    v_mul_f32 v0, v0, v253
    v_mul_f32 v1, v1, v253
    v_mul_f32 v2, v2, v253
    v_mfma_f32_16x16x32_bf16 v[44:47], v[232:235], v[204:207], v[44:47]
    ds_read_b128 v[228:231], v251 offset:11264
    v_mul_f32 v3, v3, v253
    s_waitcnt lgkmcnt(2)
    v_mfma_f32_16x16x32_bf16 v[8:11], v[236:239], v[80:83], v[8:11]
    v_mul_f32 v4, v4, v253
    v_mul_f32 v5, v5, v253
    v_mfma_f32_16x16x32_bf16 v[40:43], v[236:239], v[84:87], v[40:43]
    ds_read_b128 v[232:235], v250 offset:36864
    v_mul_f32 v6, v6, v253
    v_mfma_f32_16x16x32_bf16 v[12:15], v[240:243], v[80:83], v[12:15]
    v_mul_f32 v7, v7, v253
    v_cvt_pk_bf16_f32 v128, v0, v1
    v_mfma_f32_16x16x32_bf16 v[44:47], v[240:243], v[84:87], v[44:47]
    ds_read_b128 v[236:239], v250 offset:37888
    s_waitcnt lgkmcnt(2)
    v_mfma_f32_16x16x32_bf16 v[8:11], v[244:247], v[88:91], v[8:11]
    v_cvt_pk_bf16_f32 v129, v2, v3
    v_cvt_pk_bf16_f32 v130, v4, v5
    v_mfma_f32_16x16x32_bf16 v[40:43], v[244:247], v[92:95], v[40:43]
    ds_read_b128 v[240:243], v250 offset:45056
    v_cvt_pk_bf16_f32 v131, v6, v7
    v_mfma_f32_16x16x32_bf16 v[12:15], v[228:231], v[88:91], v[12:15]
    buffer_store_dwordx4 v[128:131], v252, s[16:19], s25 offen offset:0 sc1
    v_mul_f32 v32, v32, v254
    v_mfma_f32_16x16x32_bf16 v[44:47], v[228:231], v[92:95], v[44:47]
    ds_read_b128 v[244:247], v250 offset:46080
    s_waitcnt lgkmcnt(2)
    v_mfma_f32_16x16x32_bf16 v[16:19], v[232:235], v[64:67], v[16:19]
    v_mul_f32 v33, v33, v254
    v_mul_f32 v34, v34, v254
    v_mfma_f32_16x16x32_bf16 v[48:51], v[232:235], v[68:71], v[48:51]
    ds_read_b128 v[228:231], v250 offset:53248
    v_mul_f32 v35, v35, v254
    v_mfma_f32_16x16x32_bf16 v[20:23], v[236:239], v[64:67], v[20:23]
    v_mul_f32 v36, v36, v254
    v_mul_f32 v37, v37, v254
    v_mul_f32 v38, v38, v254
    v_mfma_f32_16x16x32_bf16 v[52:55], v[236:239], v[68:71], v[52:55]
    ds_read_b128 v[232:235], v250 offset:54272
    v_mul_f32 v39, v39, v254
    s_waitcnt lgkmcnt(2)
    v_mfma_f32_16x16x32_bf16 v[16:19], v[240:243], v[72:75], v[16:19]
    v_cvt_pk_bf16_f32 v144, v32, v33
    v_cvt_pk_bf16_f32 v145, v34, v35
    v_cvt_pk_bf16_f32 v146, v36, v37
    v_mfma_f32_16x16x32_bf16 v[48:51], v[240:243], v[76:79], v[48:51]
    ds_read_b128 v[236:239], v250 offset:61440
    v_cvt_pk_bf16_f32 v147, v38, v39
    buffer_store_dwordx4 v[144:147], v252, s[16:19], s26 offen offset:0 sc1
    v_mfma_f32_16x16x32_bf16 v[20:23], v[244:247], v[72:75], v[20:23]
    v_mul_f32 v8, v8, v253
    v_mul_f32 v9, v9, v253
    v_mul_f32 v10, v10, v253
    v_mfma_f32_16x16x32_bf16 v[52:55], v[244:247], v[76:79], v[52:55]
    ds_read_b128 v[240:243], v250 offset:62464
    v_mul_f32 v11, v11, v253
    s_waitcnt lgkmcnt(2)
    v_mfma_f32_16x16x32_bf16 v[16:19], v[228:231], v[192:195], v[16:19]
    v_mul_f32 v12, v12, v253
    v_mul_f32 v13, v13, v253
    v_mul_f32 v14, v14, v253
    v_mfma_f32_16x16x32_bf16 v[48:51], v[228:231], v[196:199], v[48:51]
    ds_read_b128 v[244:247], v251 offset:4096
    v_mul_f32 v15, v15, v253
    v_cvt_pk_bf16_f32 v132, v8, v9
    v_mfma_f32_16x16x32_bf16 v[20:23], v[232:235], v[192:195], v[20:23]
    v_cvt_pk_bf16_f32 v133, v10, v11
    v_cvt_pk_bf16_f32 v134, v12, v13
    v_cvt_pk_bf16_f32 v135, v14, v15
    v_mfma_f32_16x16x32_bf16 v[52:55], v[232:235], v[196:199], v[52:55]
    ds_read_b128 v[228:231], v251 offset:5120
    buffer_store_dwordx4 v[132:135], v252, s[16:19], s25 offen offset:64 sc1
    s_waitcnt lgkmcnt(2)
    v_mfma_f32_16x16x32_bf16 v[16:19], v[236:239], v[200:203], v[16:19]
    v_mul_f32 v40, v40, v254
    v_mul_f32 v41, v41, v254
    v_mul_f32 v42, v42, v254
    v_mfma_f32_16x16x32_bf16 v[48:51], v[236:239], v[204:207], v[48:51]
    ds_read_b128 v[232:235], v251 offset:12288
    v_mul_f32 v43, v43, v254
    v_mfma_f32_16x16x32_bf16 v[20:23], v[240:243], v[200:203], v[20:23]
    v_mul_f32 v44, v44, v254
    v_mul_f32 v45, v45, v254
    v_mfma_f32_16x16x32_bf16 v[52:55], v[240:243], v[204:207], v[52:55]
    ds_read_b128 v[236:239], v251 offset:13312
    s_waitcnt lgkmcnt(2)
    v_mfma_f32_16x16x32_bf16 v[16:19], v[244:247], v[80:83], v[16:19]
    v_mul_f32 v46, v46, v254
    v_mul_f32 v47, v47, v254
    v_mfma_f32_16x16x32_bf16 v[48:51], v[244:247], v[84:87], v[48:51]
    ds_read_b128 v[240:243], v250 offset:38912
    v_cvt_pk_bf16_f32 v148, v40, v41
    v_mfma_f32_16x16x32_bf16 v[20:23], v[228:231], v[80:83], v[20:23]
    v_cvt_pk_bf16_f32 v149, v42, v43
    v_cvt_pk_bf16_f32 v150, v44, v45
    v_mfma_f32_16x16x32_bf16 v[52:55], v[228:231], v[84:87], v[52:55]
    ds_read_b128 v[244:247], v250 offset:39936
    s_waitcnt lgkmcnt(2)
    v_mfma_f32_16x16x32_bf16 v[16:19], v[232:235], v[88:91], v[16:19]
    v_cvt_pk_bf16_f32 v151, v46, v47
    buffer_store_dwordx4 v[148:151], v252, s[16:19], s26 offen offset:64 sc1
    v_mfma_f32_16x16x32_bf16 v[48:51], v[232:235], v[92:95], v[48:51]
    ds_read_b128 v[228:231], v250 offset:47104
    v_mfma_f32_16x16x32_bf16 v[20:23], v[236:239], v[88:91], v[20:23]
    v_mfma_f32_16x16x32_bf16 v[52:55], v[236:239], v[92:95], v[52:55]
    ds_read_b128 v[232:235], v250 offset:48128
    s_waitcnt lgkmcnt(2)
    v_mfma_f32_16x16x32_bf16 v[24:27], v[240:243], v[64:67], v[24:27]
    v_mfma_f32_16x16x32_bf16 v[56:59], v[240:243], v[68:71], v[56:59]
    ds_read_b128 v[236:239], v250 offset:55296
    v_mfma_f32_16x16x32_bf16 v[28:31], v[244:247], v[64:67], v[28:31]
    v_mul_f32 v16, v16, v253
    v_mul_f32 v17, v17, v253
    v_mul_f32 v18, v18, v253
    v_mfma_f32_16x16x32_bf16 v[60:63], v[244:247], v[68:71], v[60:63]
    ds_read_b128 v[240:243], v250 offset:56320
    v_mul_f32 v19, v19, v253
    s_waitcnt lgkmcnt(2)
    v_mfma_f32_16x16x32_bf16 v[24:27], v[228:231], v[72:75], v[24:27]
    v_mul_f32 v20, v20, v253
    v_mul_f32 v21, v21, v253
    v_mfma_f32_16x16x32_bf16 v[56:59], v[228:231], v[76:79], v[56:59]
    ds_read_b128 v[244:247], v250 offset:63488
    v_mul_f32 v22, v22, v253
    v_mfma_f32_16x16x32_bf16 v[28:31], v[232:235], v[72:75], v[28:31]
    v_mul_f32 v23, v23, v253
    v_cvt_pk_bf16_f32 v136, v16, v17
    v_mfma_f32_16x16x32_bf16 v[60:63], v[232:235], v[76:79], v[60:63]
    ds_read_b128 v[228:231], v250 offset:64512
    s_waitcnt lgkmcnt(2)
    v_mfma_f32_16x16x32_bf16 v[24:27], v[236:239], v[192:195], v[24:27]
    v_cvt_pk_bf16_f32 v137, v18, v19
    v_cvt_pk_bf16_f32 v138, v20, v21
    v_mfma_f32_16x16x32_bf16 v[56:59], v[236:239], v[196:199], v[56:59]
    ds_read_b128 v[232:235], v251 offset:6144
    v_cvt_pk_bf16_f32 v139, v22, v23
    v_mfma_f32_16x16x32_bf16 v[28:31], v[240:243], v[192:195], v[28:31]
    buffer_store_dwordx4 v[136:139], v252, s[16:19], s25 offen offset:128 sc1
    v_mul_f32 v48, v48, v254
    v_mfma_f32_16x16x32_bf16 v[60:63], v[240:243], v[196:199], v[60:63]
    ds_read_b128 v[236:239], v251 offset:7168
    s_waitcnt lgkmcnt(2)
    v_mfma_f32_16x16x32_bf16 v[24:27], v[244:247], v[200:203], v[24:27]
    v_mul_f32 v49, v49, v254
    v_mul_f32 v50, v50, v254
    v_mfma_f32_16x16x32_bf16 v[56:59], v[244:247], v[204:207], v[56:59]
    ds_read_b128 v[240:243], v251 offset:14336
    v_mul_f32 v51, v51, v254
    v_mfma_f32_16x16x32_bf16 v[28:31], v[228:231], v[200:203], v[28:31]
    v_mul_f32 v52, v52, v254
    v_mul_f32 v53, v53, v254
    v_mfma_f32_16x16x32_bf16 v[60:63], v[228:231], v[204:207], v[60:63]
    ds_read_b128 v[244:247], v251 offset:15360
    s_waitcnt lgkmcnt(2)
    v_mfma_f32_16x16x32_bf16 v[24:27], v[232:235], v[80:83], v[24:27]
    v_mul_f32 v54, v54, v254
    v_mul_f32 v55, v55, v254
    v_mfma_f32_16x16x32_bf16 v[56:59], v[232:235], v[84:87], v[56:59]
    v_cvt_pk_bf16_f32 v152, v48, v49
    v_mfma_f32_16x16x32_bf16 v[28:31], v[236:239], v[80:83], v[28:31]
    v_cvt_pk_bf16_f32 v153, v50, v51
    v_cvt_pk_bf16_f32 v154, v52, v53
    v_mfma_f32_16x16x32_bf16 v[60:63], v[236:239], v[84:87], v[60:63]
    s_waitcnt lgkmcnt(0)
    v_mfma_f32_16x16x32_bf16 v[24:27], v[240:243], v[88:91], v[24:27]
    v_cvt_pk_bf16_f32 v155, v54, v55
    buffer_store_dwordx4 v[152:155], v252, s[16:19], s26 offen offset:128 sc1
    v_mfma_f32_16x16x32_bf16 v[56:59], v[240:243], v[92:95], v[56:59]
    v_mfma_f32_16x16x32_bf16 v[28:31], v[244:247], v[88:91], v[28:31]
    v_mfma_f32_16x16x32_bf16 v[60:63], v[244:247], v[92:95], v[60:63]
    s_nop 2
    v_mul_f32 v24, v24, v253
    v_mul_f32 v25, v25, v253
    v_mul_f32 v26, v26, v253
    v_mul_f32 v27, v27, v253
    v_mul_f32 v28, v28, v253
    v_mul_f32 v29, v29, v253
    v_mul_f32 v30, v30, v253
    v_mul_f32 v31, v31, v253
    v_cvt_pk_bf16_f32 v140, v24, v25
    v_cvt_pk_bf16_f32 v141, v26, v27
    v_cvt_pk_bf16_f32 v142, v28, v29
    v_cvt_pk_bf16_f32 v143, v30, v31
    buffer_store_dwordx4 v[140:143], v252, s[16:19], s25 offen offset:192 sc1
    v_mul_f32 v56, v56, v254
    v_mul_f32 v57, v57, v254
    v_mul_f32 v58, v58, v254
    v_mul_f32 v59, v59, v254
    v_mul_f32 v60, v60, v254
    v_mul_f32 v61, v61, v254
    v_mul_f32 v62, v62, v254
    v_mul_f32 v63, v63, v254
    v_cvt_pk_bf16_f32 v156, v56, v57
    v_cvt_pk_bf16_f32 v157, v58, v59
    v_cvt_pk_bf16_f32 v158, v60, v61
    v_cvt_pk_bf16_f32 v159, v62, v63
    buffer_store_dwordx4 v[156:159], v252, s[16:19], s26 offen offset:192 sc1
L_done:
L_end:
    s_endpgm
L_b0:
    ds_read_b128 v[228:231], v248 offset:0
    ds_read_b128 v[232:235], v248 offset:1024
    ds_read_b128 v[236:239], v248 offset:2048
    ds_read_b128 v[240:243], v248 offset:3072
    s_setprio 3
    s_waitcnt lgkmcnt(2)
    v_mfma_f32_16x16x32_bf16 v[160:163], v[228:231], v[64:67], 0
    v_mfma_f32_16x16x32_bf16 v[168:171], v[228:231], v[80:83], 0
    ds_read_b128 v[244:247], v248 offset:4096
    v_mfma_f32_16x16x32_bf16 v[160:163], v[232:235], v[68:71], v[160:163]
    v_mfma_f32_16x16x32_bf16 v[168:171], v[232:235], v[84:87], v[168:171]
    ds_read_b128 v[228:231], v248 offset:5120
    s_waitcnt lgkmcnt(2)
    v_mfma_f32_16x16x32_bf16 v[160:163], v[236:239], v[72:75], v[160:163]
    v_mfma_f32_16x16x32_bf16 v[168:171], v[236:239], v[88:91], v[168:171]
    ds_read_b128 v[232:235], v248 offset:6144
    v_mfma_f32_16x16x32_bf16 v[160:163], v[240:243], v[76:79], v[160:163]
    v_mfma_f32_16x16x32_bf16 v[168:171], v[240:243], v[92:95], v[168:171]
    ds_read_b128 v[236:239], v248 offset:7168
    s_waitcnt lgkmcnt(2)
    v_mfma_f32_16x16x32_bf16 v[164:167], v[244:247], v[64:67], 0
    v_mfma_f32_16x16x32_bf16 v[172:175], v[244:247], v[80:83], 0
    ds_read_b128 v[240:243], v248 offset:8192
    v_mfma_f32_16x16x32_bf16 v[164:167], v[228:231], v[68:71], v[164:167]
    s_nop 0
    v_max3_f32 v208, v160, v161, v162
    v_max3_f32 v212, v168, v169, v170
    v_mfma_f32_16x16x32_bf16 v[172:175], v[228:231], v[84:87], v[172:175]
    ds_read_b128 v[244:247], v248 offset:9216
    s_waitcnt lgkmcnt(2)
    v_mfma_f32_16x16x32_bf16 v[164:167], v[232:235], v[72:75], v[164:167]
    v_mfma_f32_16x16x32_bf16 v[172:175], v[232:235], v[88:91], v[172:175]
    ds_read_b128 v[228:231], v248 offset:10240
    v_mfma_f32_16x16x32_bf16 v[164:167], v[236:239], v[76:79], v[164:167]
    v_mfma_f32_16x16x32_bf16 v[172:175], v[236:239], v[92:95], v[172:175]
    ds_read_b128 v[232:235], v248 offset:11264
    s_waitcnt lgkmcnt(2)
    v_mfma_f32_16x16x32_bf16 v[176:179], v[240:243], v[64:67], 0
    v_mfma_f32_16x16x32_bf16 v[184:187], v[240:243], v[80:83], 0
    ds_read_b128 v[236:239], v248 offset:12288
    v_mfma_f32_16x16x32_bf16 v[176:179], v[244:247], v[68:71], v[176:179]
    s_nop 0
    v_max3_f32 v208, v163, v164, v208
    v_max3_f32 v212, v171, v172, v212
    v_max3_f32 v208, v165, v166, v208
    v_max3_f32 v212, v173, v174, v212
    v_max_f32 v208, v167, v208
    v_max_f32 v212, v175, v212
    s_nop 1
    v_permlane16_swap_b32 v208, v212
    v_mfma_f32_16x16x32_bf16 v[184:187], v[244:247], v[84:87], v[184:187]
    ds_read_b128 v[240:243], v248 offset:13312
    v_max_f32 v208, v208, v212
    v_mov_b32 v212, v208
    s_nop 1
    v_permlane32_swap_b32 v208, v212
    v_max_f32 v208, v208, v212
    v_mov_b32 v212, v208
    s_waitcnt lgkmcnt(2)
    v_mfma_f32_16x16x32_bf16 v[176:179], v[228:231], v[72:75], v[176:179]
    v_permlane16_swap_b32 v208, v212
    v_sub_f32 v209, 0, v208
    v_sub_f32 v210, 0, v208
    v_sub_f32 v211, 0, v208
    v_sub_f32 v208, 0, v208
    v_sub_f32 v213, 0, v212
    v_sub_f32 v214, 0, v212
    v_mfma_f32_16x16x32_bf16 v[184:187], v[228:231], v[88:91], v[184:187]
    ds_read_b128 v[244:247], v248 offset:14336
    v_sub_f32 v215, 0, v212
    v_sub_f32 v212, 0, v212
    v_add_f32 v160, v160, v208
    v_exp_f32 v160, v160
    v_add_f32 v161, v161, v208
    v_mfma_f32_16x16x32_bf16 v[176:179], v[232:235], v[76:79], v[176:179]
    v_exp_f32 v161, v161
    v_add_f32 v162, v162, v208
    v_exp_f32 v162, v162
    v_add_f32 v163, v163, v208
    v_add_f32 v168, v168, v212
    v_mfma_f32_16x16x32_bf16 v[184:187], v[232:235], v[92:95], v[184:187]
    ds_read_b128 v[228:231], v248 offset:15360
    v_cvt_pk_bf16_f32 v192, v160, v161
    v_exp_f32 v163, v163
    v_exp_f32 v168, v168
    s_waitcnt lgkmcnt(2)
    v_mfma_f32_16x16x32_bf16 v[180:183], v[236:239], v[64:67], 0
    v_cvt_pk_bf16_f32 v193, v162, v163
    v_add_f32 v169, v169, v212
    v_exp_f32 v169, v169
    v_add_f32 v170, v170, v212
    v_exp_f32 v170, v170
    v_mfma_f32_16x16x32_bf16 v[188:191], v[236:239], v[80:83], 0
    ds_read_b128 v[232:235], v250 offset:0
    v_cvt_pk_bf16_f32 v196, v168, v169
    v_add_f32 v171, v171, v212
    v_exp_f32 v171, v171
    v_add_f32 v164, v164, v208
    v_add_f32 v165, v165, v208
    v_mfma_f32_16x16x32_bf16 v[180:183], v[240:243], v[68:71], v[180:183]
    v_exp_f32 v164, v164
    v_cvt_pk_bf16_f32 v197, v170, v171
    v_exp_f32 v165, v165
    v_add_f32 v166, v166, v208
    v_mfma_f32_16x16x32_bf16 v[188:191], v[240:243], v[84:87], v[188:191]
    ds_read_b128 v[236:239], v250 offset:1024
    v_cvt_pk_bf16_f32 v194, v164, v165
    v_exp_f32 v166, v166
    v_add_f32 v167, v167, v208
    s_waitcnt lgkmcnt(2)
    v_mfma_f32_16x16x32_bf16 v[180:183], v[244:247], v[72:75], v[180:183]
    v_exp_f32 v167, v167
    v_add_f32 v172, v172, v212
    v_exp_f32 v172, v172
    v_add_f32 v173, v173, v212
    v_mfma_f32_16x16x32_bf16 v[188:191], v[244:247], v[88:91], v[188:191]
    ds_read_b128 v[240:243], v250 offset:2048
    v_cvt_pk_bf16_f32 v195, v166, v167
    v_exp_f32 v173, v173
    v_add_f32 v174, v174, v212
    v_add_f32 v175, v175, v212
    v_mfma_f32_16x16x32_bf16 v[180:183], v[228:231], v[76:79], v[180:183]
    v_exp_f32 v174, v174
    v_cvt_pk_bf16_f32 v198, v172, v173
    v_exp_f32 v175, v175
    v_add_f32 v176, v176, v208
    v_mfma_f32_16x16x32_bf16 v[188:191], v[228:231], v[92:95], v[188:191]
    ds_read_b128 v[244:247], v250 offset:3072
    v_cvt_pk_bf16_f32 v199, v174, v175
    s_setprio 1
    v_mfma_f32_16x16x32_bf16 v[216:219], v[224:227], v[192:195], 0
    v_exp_f32 v176, v176
    v_mfma_f32_16x16x32_bf16 v[220:223], v[224:227], v[196:199], 0
    s_waitcnt lgkmcnt(2)
    v_mfma_f32_16x16x32_bf16 v[0:3], v[232:235], v[192:195], 0
    v_add_f32 v177, v177, v208
    v_add_f32 v178, v178, v208
    v_add_f32 v179, v179, v208
    v_mfma_f32_16x16x32_bf16 v[32:35], v[232:235], v[196:199], 0
    ds_read_b128 v[228:231], v250 offset:4096
    v_add_f32 v184, v184, v212
    v_add_f32 v185, v185, v212
    s_setprio 2
    v_mfma_f32_16x16x32_bf16 v[4:7], v[236:239], v[192:195], 0
    v_exp_f32 v177, v177
    v_add_f32 v186, v186, v212
    v_mfma_f32_16x16x32_bf16 v[36:39], v[236:239], v[196:199], 0
    ds_read_b128 v[232:235], v250 offset:5120
    v_cvt_pk_bf16_f32 v200, v176, v177
    s_waitcnt lgkmcnt(2)
    v_mfma_f32_16x16x32_bf16 v[8:11], v[240:243], v[192:195], 0
    v_exp_f32 v178, v178
    v_add_f32 v187, v187, v212
    v_mfma_f32_16x16x32_bf16 v[40:43], v[240:243], v[196:199], 0
    ds_read_b128 v[236:239], v250 offset:6144
    buffer_load_dwordx4 v[96:99], v252, s[4:7], s23 offen offset:0 nt
    v_add_f32 v180, v180, v208
    v_mfma_f32_16x16x32_bf16 v[12:15], v[244:247], v[192:195], 0
    v_exp_f32 v179, v179
    v_add_f32 v181, v181, v208
    v_mfma_f32_16x16x32_bf16 v[44:47], v[244:247], v[196:199], 0
    ds_read_b128 v[240:243], v250 offset:7168
    v_cvt_pk_bf16_f32 v201, v178, v179
    s_waitcnt lgkmcnt(2)
    v_mfma_f32_16x16x32_bf16 v[16:19], v[228:231], v[192:195], 0
    v_exp_f32 v184, v184
    v_add_f32 v182, v182, v208
    v_mfma_f32_16x16x32_bf16 v[48:51], v[228:231], v[196:199], 0
    ds_read_b128 v[244:247], v248 offset:16384
    v_add_f32 v183, v183, v208
    v_add_f32 v188, v188, v212
    v_mfma_f32_16x16x32_bf16 v[20:23], v[232:235], v[192:195], 0
    v_exp_f32 v185, v185
    v_add_f32 v189, v189, v212
    v_mfma_f32_16x16x32_bf16 v[52:55], v[232:235], v[196:199], 0
    ds_read_b128 v[228:231], v248 offset:17408
    buffer_load_dwordx4 v[100:103], v252, s[4:7], s23 offen offset:64 nt
    v_cvt_pk_bf16_f32 v204, v184, v185
    s_waitcnt lgkmcnt(2)
    v_mfma_f32_16x16x32_bf16 v[24:27], v[236:239], v[192:195], 0
    v_exp_f32 v186, v186
    v_add_f32 v190, v190, v212
    v_mfma_f32_16x16x32_bf16 v[56:59], v[236:239], v[196:199], 0
    ds_read_b128 v[232:235], v248 offset:18432
    v_add_f32 v191, v191, v212
    v_mfma_f32_16x16x32_bf16 v[28:31], v[240:243], v[192:195], 0
    v_exp_f32 v187, v187
    v_mfma_f32_16x16x32_bf16 v[60:63], v[240:243], v[196:199], 0
    ds_read_b128 v[236:239], v248 offset:19456
    v_cvt_pk_bf16_f32 v205, v186, v187
    s_waitcnt lgkmcnt(2)
    v_mfma_f32_16x16x32_bf16 v[160:163], v[244:247], v[64:67], v[208:211]
    v_exp_f32 v180, v180
    v_mfma_f32_16x16x32_bf16 v[168:171], v[244:247], v[80:83], v[212:215]
    ds_read_b128 v[240:243], v248 offset:20480
    buffer_load_dwordx4 v[104:107], v252, s[4:7], s23 offen offset:128 nt
    v_mfma_f32_16x16x32_bf16 v[160:163], v[228:231], v[68:71], v[160:163]
    v_exp_f32 v181, v181
    v_mfma_f32_16x16x32_bf16 v[168:171], v[228:231], v[84:87], v[168:171]
    ds_read_b128 v[244:247], v248 offset:21504
    v_cvt_pk_bf16_f32 v202, v180, v181
    s_waitcnt lgkmcnt(2)
    v_mfma_f32_16x16x32_bf16 v[160:163], v[232:235], v[72:75], v[160:163]
    v_exp_f32 v182, v182
    v_mfma_f32_16x16x32_bf16 v[168:171], v[232:235], v[88:91], v[168:171]
    ds_read_b128 v[228:231], v248 offset:22528
    v_exp_f32 v183, v183
    v_mfma_f32_16x16x32_bf16 v[160:163], v[236:239], v[76:79], v[160:163]
    v_exp_f32 v188, v188
    v_mfma_f32_16x16x32_bf16 v[168:171], v[236:239], v[92:95], v[168:171]
    ds_read_b128 v[232:235], v248 offset:23552
    buffer_load_dwordx4 v[108:111], v252, s[4:7], s23 offen offset:192 nt
    s_waitcnt lgkmcnt(2)
    v_mfma_f32_16x16x32_bf16 v[164:167], v[240:243], v[64:67], v[208:211]
    v_exp_f32 v189, v189
    v_mfma_f32_16x16x32_bf16 v[172:175], v[240:243], v[80:83], v[212:215]
    ds_read_b128 v[236:239], v250 offset:8192
    v_cvt_pk_bf16_f32 v203, v182, v183
    v_mfma_f32_16x16x32_bf16 v[164:167], v[244:247], v[68:71], v[164:167]
    v_exp_f32 v190, v190
    v_mfma_f32_16x16x32_bf16 v[172:175], v[244:247], v[84:87], v[172:175]
    ds_read_b128 v[240:243], v250 offset:9216
    s_waitcnt lgkmcnt(2)
    v_mfma_f32_16x16x32_bf16 v[164:167], v[228:231], v[72:75], v[164:167]
    v_exp_f32 v191, v191
    v_mfma_f32_16x16x32_bf16 v[172:175], v[228:231], v[88:91], v[172:175]
    ds_read_b128 v[244:247], v250 offset:10240
    buffer_load_dwordx4 v[112:115], v252, s[4:7], s24 offen offset:0 nt
    v_mfma_f32_16x16x32_bf16 v[164:167], v[232:235], v[76:79], v[164:167]
    v_exp_f32 v160, v160
    v_mfma_f32_16x16x32_bf16 v[172:175], v[232:235], v[92:95], v[172:175]
    ds_read_b128 v[228:231], v250 offset:11264
    v_cvt_pk_bf16_f32 v206, v188, v189
    v_cvt_pk_bf16_f32 v207, v190, v191
    v_mfma_f32_16x16x32_bf16 v[216:219], v[224:227], v[200:203], v[216:219]
    v_exp_f32 v161, v161
    v_mfma_f32_16x16x32_bf16 v[220:223], v[224:227], v[204:207], v[220:223]
    s_waitcnt lgkmcnt(2)
    v_mfma_f32_16x16x32_bf16 v[0:3], v[236:239], v[200:203], v[0:3]
    v_exp_f32 v162, v162
    v_mfma_f32_16x16x32_bf16 v[32:35], v[236:239], v[204:207], v[32:35]
    ds_read_b128 v[232:235], v250 offset:12288
    v_cvt_pk_bf16_f32 v192, v160, v161
    v_mfma_f32_16x16x32_bf16 v[4:7], v[240:243], v[200:203], v[4:7]
    v_exp_f32 v163, v163
    v_mfma_f32_16x16x32_bf16 v[36:39], v[240:243], v[204:207], v[36:39]
    ds_read_b128 v[236:239], v250 offset:13312
    buffer_load_dwordx4 v[116:119], v252, s[4:7], s24 offen offset:64 nt
    s_waitcnt lgkmcnt(2)
    v_mfma_f32_16x16x32_bf16 v[8:11], v[244:247], v[200:203], v[8:11]
    v_exp_f32 v168, v168
    v_mfma_f32_16x16x32_bf16 v[40:43], v[244:247], v[204:207], v[40:43]
    ds_read_b128 v[240:243], v250 offset:14336
    v_cvt_pk_bf16_f32 v193, v162, v163
    v_mfma_f32_16x16x32_bf16 v[12:15], v[228:231], v[200:203], v[12:15]
    v_exp_f32 v169, v169
    v_mfma_f32_16x16x32_bf16 v[44:47], v[228:231], v[204:207], v[44:47]
    ds_read_b128 v[244:247], v250 offset:15360
    s_waitcnt lgkmcnt(2)
    v_mfma_f32_16x16x32_bf16 v[16:19], v[232:235], v[200:203], v[16:19]
    v_exp_f32 v170, v170
    v_mfma_f32_16x16x32_bf16 v[48:51], v[232:235], v[204:207], v[48:51]
    ds_read_b128 v[228:231], v248 offset:24576
    buffer_load_dwordx4 v[120:123], v252, s[4:7], s24 offen offset:128 nt
    v_mfma_f32_16x16x32_bf16 v[20:23], v[236:239], v[200:203], v[20:23]
    v_exp_f32 v171, v171
    v_mfma_f32_16x16x32_bf16 v[52:55], v[236:239], v[204:207], v[52:55]
    ds_read_b128 v[232:235], v248 offset:25600
    s_waitcnt lgkmcnt(2)
    v_mfma_f32_16x16x32_bf16 v[24:27], v[240:243], v[200:203], v[24:27]
    v_exp_f32 v164, v164
    v_mfma_f32_16x16x32_bf16 v[56:59], v[240:243], v[204:207], v[56:59]
    ds_read_b128 v[236:239], v248 offset:26624
    v_cvt_pk_bf16_f32 v196, v168, v169
    v_mfma_f32_16x16x32_bf16 v[28:31], v[244:247], v[200:203], v[28:31]
    v_exp_f32 v165, v165
    v_mfma_f32_16x16x32_bf16 v[60:63], v[244:247], v[204:207], v[60:63]
    ds_read_b128 v[240:243], v248 offset:27648
    buffer_load_dwordx4 v[124:127], v252, s[4:7], s24 offen offset:192 nt
    s_waitcnt lgkmcnt(2)
    v_mfma_f32_16x16x32_bf16 v[176:179], v[228:231], v[64:67], v[208:211]
    v_exp_f32 v166, v166
    v_mfma_f32_16x16x32_bf16 v[184:187], v[228:231], v[80:83], v[212:215]
    ds_read_b128 v[244:247], v248 offset:28672
    v_cvt_pk_bf16_f32 v197, v170, v171
    v_mfma_f32_16x16x32_bf16 v[176:179], v[232:235], v[68:71], v[176:179]
    v_exp_f32 v167, v167
    v_mfma_f32_16x16x32_bf16 v[184:187], v[232:235], v[84:87], v[184:187]
    ds_read_b128 v[228:231], v248 offset:29696
    s_waitcnt lgkmcnt(2)
    v_mfma_f32_16x16x32_bf16 v[176:179], v[236:239], v[72:75], v[176:179]
    v_exp_f32 v172, v172
    v_mfma_f32_16x16x32_bf16 v[184:187], v[236:239], v[88:91], v[184:187]
    ds_read_b128 v[232:235], v248 offset:30720
    v_cvt_pk_bf16_f32 v194, v164, v165
    v_mfma_f32_16x16x32_bf16 v[176:179], v[240:243], v[76:79], v[176:179]
    v_exp_f32 v173, v173
    v_mfma_f32_16x16x32_bf16 v[184:187], v[240:243], v[92:95], v[184:187]
    ds_read_b128 v[236:239], v248 offset:31744
    s_waitcnt lgkmcnt(2)
    v_mfma_f32_16x16x32_bf16 v[180:183], v[244:247], v[64:67], v[208:211]
    v_exp_f32 v174, v174
    v_mfma_f32_16x16x32_bf16 v[188:191], v[244:247], v[80:83], v[212:215]
    ds_read_b128 v[240:243], v250 offset:16384
    v_cvt_pk_bf16_f32 v195, v166, v167
    v_mfma_f32_16x16x32_bf16 v[180:183], v[228:231], v[68:71], v[180:183]
    v_exp_f32 v175, v175
    v_mfma_f32_16x16x32_bf16 v[188:191], v[228:231], v[84:87], v[188:191]
    ds_read_b128 v[244:247], v250 offset:17408
    s_waitcnt lgkmcnt(2)
    v_mfma_f32_16x16x32_bf16 v[180:183], v[232:235], v[72:75], v[180:183]
    v_exp_f32 v176, v176
    v_mfma_f32_16x16x32_bf16 v[188:191], v[232:235], v[88:91], v[188:191]
    ds_read_b128 v[228:231], v250 offset:18432
    v_cvt_pk_bf16_f32 v198, v172, v173
    v_mfma_f32_16x16x32_bf16 v[180:183], v[236:239], v[76:79], v[180:183]
    v_exp_f32 v177, v177
    v_mfma_f32_16x16x32_bf16 v[188:191], v[236:239], v[92:95], v[188:191]
    ds_read_b128 v[232:235], v250 offset:19456
    v_cvt_pk_bf16_f32 v199, v174, v175
    v_mfma_f32_16x16x32_bf16 v[216:219], v[224:227], v[192:195], v[216:219]
    v_exp_f32 v178, v178
    v_mfma_f32_16x16x32_bf16 v[220:223], v[224:227], v[196:199], v[220:223]
    s_waitcnt lgkmcnt(2)
    v_mfma_f32_16x16x32_bf16 v[0:3], v[240:243], v[192:195], v[0:3]
    v_exp_f32 v179, v179
    v_mfma_f32_16x16x32_bf16 v[32:35], v[240:243], v[196:199], v[32:35]
    ds_read_b128 v[236:239], v250 offset:20480
    v_cvt_pk_bf16_f32 v200, v176, v177
    v_mfma_f32_16x16x32_bf16 v[4:7], v[244:247], v[192:195], v[4:7]
    v_exp_f32 v184, v184
    v_mfma_f32_16x16x32_bf16 v[36:39], v[244:247], v[196:199], v[36:39]
    ds_read_b128 v[240:243], v250 offset:21504
    s_waitcnt lgkmcnt(2)
    v_mfma_f32_16x16x32_bf16 v[8:11], v[228:231], v[192:195], v[8:11]
    v_exp_f32 v185, v185
    v_mfma_f32_16x16x32_bf16 v[40:43], v[228:231], v[196:199], v[40:43]
    ds_read_b128 v[244:247], v250 offset:22528
    v_cvt_pk_bf16_f32 v201, v178, v179
    v_mfma_f32_16x16x32_bf16 v[12:15], v[232:235], v[192:195], v[12:15]
    v_exp_f32 v186, v186
    v_mfma_f32_16x16x32_bf16 v[44:47], v[232:235], v[196:199], v[44:47]
    ds_read_b128 v[228:231], v250 offset:23552
    s_waitcnt lgkmcnt(2)
    v_mfma_f32_16x16x32_bf16 v[16:19], v[236:239], v[192:195], v[16:19]
    v_exp_f32 v187, v187
    v_mfma_f32_16x16x32_bf16 v[48:51], v[236:239], v[196:199], v[48:51]
    ds_read_b128 v[232:235], v248 offset:32768
    v_cvt_pk_bf16_f32 v204, v184, v185
    v_mfma_f32_16x16x32_bf16 v[20:23], v[240:243], v[192:195], v[20:23]
    v_exp_f32 v180, v180
    v_mfma_f32_16x16x32_bf16 v[52:55], v[240:243], v[196:199], v[52:55]
    ds_read_b128 v[236:239], v248 offset:33792
    s_waitcnt lgkmcnt(2)
    v_mfma_f32_16x16x32_bf16 v[24:27], v[244:247], v[192:195], v[24:27]
    v_exp_f32 v181, v181
    v_mfma_f32_16x16x32_bf16 v[56:59], v[244:247], v[196:199], v[56:59]
    ds_read_b128 v[240:243], v248 offset:34816
    v_cvt_pk_bf16_f32 v205, v186, v187
    v_mfma_f32_16x16x32_bf16 v[28:31], v[228:231], v[192:195], v[28:31]
    v_exp_f32 v182, v182
    v_mfma_f32_16x16x32_bf16 v[60:63], v[228:231], v[196:199], v[60:63]
    ds_read_b128 v[244:247], v248 offset:35840
    s_waitcnt lgkmcnt(2)
    v_mfma_f32_16x16x32_bf16 v[160:163], v[232:235], v[64:67], v[208:211]
    v_exp_f32 v183, v183
    v_mfma_f32_16x16x32_bf16 v[168:171], v[232:235], v[80:83], v[212:215]
    ds_read_b128 v[228:231], v248 offset:36864
    v_cvt_pk_bf16_f32 v202, v180, v181
    v_mfma_f32_16x16x32_bf16 v[160:163], v[236:239], v[68:71], v[160:163]
    v_exp_f32 v188, v188
    v_mfma_f32_16x16x32_bf16 v[168:171], v[236:239], v[84:87], v[168:171]
    ds_read_b128 v[232:235], v248 offset:37888
    s_waitcnt lgkmcnt(2)
    v_mfma_f32_16x16x32_bf16 v[160:163], v[240:243], v[72:75], v[160:163]
    v_exp_f32 v189, v189
    v_mfma_f32_16x16x32_bf16 v[168:171], v[240:243], v[88:91], v[168:171]
    ds_read_b128 v[236:239], v248 offset:38912
    v_cvt_pk_bf16_f32 v203, v182, v183
    v_mfma_f32_16x16x32_bf16 v[160:163], v[244:247], v[76:79], v[160:163]
    v_exp_f32 v190, v190
    v_mfma_f32_16x16x32_bf16 v[168:171], v[244:247], v[92:95], v[168:171]
    ds_read_b128 v[240:243], v248 offset:39936
    s_waitcnt lgkmcnt(2)
    v_mfma_f32_16x16x32_bf16 v[164:167], v[228:231], v[64:67], v[208:211]
    v_exp_f32 v191, v191
    v_mfma_f32_16x16x32_bf16 v[172:175], v[228:231], v[80:83], v[212:215]
    ds_read_b128 v[244:247], v250 offset:24576
    v_cvt_pk_bf16_f32 v206, v188, v189
    v_mfma_f32_16x16x32_bf16 v[164:167], v[232:235], v[68:71], v[164:167]
    v_exp_f32 v160, v160
    v_mfma_f32_16x16x32_bf16 v[172:175], v[232:235], v[84:87], v[172:175]
    ds_read_b128 v[228:231], v250 offset:25600
    s_waitcnt lgkmcnt(2)
    v_mfma_f32_16x16x32_bf16 v[164:167], v[236:239], v[72:75], v[164:167]
    v_exp_f32 v161, v161
    v_mfma_f32_16x16x32_bf16 v[172:175], v[236:239], v[88:91], v[172:175]
    ds_read_b128 v[232:235], v250 offset:26624
    v_cvt_pk_bf16_f32 v207, v190, v191
    v_mfma_f32_16x16x32_bf16 v[164:167], v[240:243], v[76:79], v[164:167]
    v_exp_f32 v162, v162
    v_mfma_f32_16x16x32_bf16 v[172:175], v[240:243], v[92:95], v[172:175]
    ds_read_b128 v[236:239], v250 offset:27648
    v_mfma_f32_16x16x32_bf16 v[216:219], v[224:227], v[200:203], v[216:219]
    v_exp_f32 v163, v163
    v_mfma_f32_16x16x32_bf16 v[220:223], v[224:227], v[204:207], v[220:223]
    s_waitcnt lgkmcnt(2)
    v_mfma_f32_16x16x32_bf16 v[0:3], v[244:247], v[200:203], v[0:3]
    v_exp_f32 v168, v168
    v_mfma_f32_16x16x32_bf16 v[32:35], v[244:247], v[204:207], v[32:35]
    ds_read_b128 v[240:243], v250 offset:28672
    v_cvt_pk_bf16_f32 v192, v160, v161
    v_mfma_f32_16x16x32_bf16 v[4:7], v[228:231], v[200:203], v[4:7]
    v_exp_f32 v169, v169
    v_mfma_f32_16x16x32_bf16 v[36:39], v[228:231], v[204:207], v[36:39]
    ds_read_b128 v[244:247], v250 offset:29696
    s_waitcnt lgkmcnt(2)
    v_mfma_f32_16x16x32_bf16 v[8:11], v[232:235], v[200:203], v[8:11]
    v_exp_f32 v170, v170
    v_mfma_f32_16x16x32_bf16 v[40:43], v[232:235], v[204:207], v[40:43]
    ds_read_b128 v[228:231], v250 offset:30720
    v_cvt_pk_bf16_f32 v193, v162, v163
    v_mfma_f32_16x16x32_bf16 v[12:15], v[236:239], v[200:203], v[12:15]
    v_exp_f32 v171, v171
    v_mfma_f32_16x16x32_bf16 v[44:47], v[236:239], v[204:207], v[44:47]
    ds_read_b128 v[232:235], v250 offset:31744
    s_waitcnt lgkmcnt(2)
    v_mfma_f32_16x16x32_bf16 v[16:19], v[240:243], v[200:203], v[16:19]
    v_exp_f32 v164, v164
    v_mfma_f32_16x16x32_bf16 v[48:51], v[240:243], v[204:207], v[48:51]
    ds_read_b128 v[236:239], v248 offset:40960
    v_cvt_pk_bf16_f32 v196, v168, v169
    v_mfma_f32_16x16x32_bf16 v[20:23], v[244:247], v[200:203], v[20:23]
    v_exp_f32 v165, v165
    v_mfma_f32_16x16x32_bf16 v[52:55], v[244:247], v[204:207], v[52:55]
    ds_read_b128 v[240:243], v248 offset:41984
    s_waitcnt lgkmcnt(2)
    v_mfma_f32_16x16x32_bf16 v[24:27], v[228:231], v[200:203], v[24:27]
    v_exp_f32 v166, v166
    v_mfma_f32_16x16x32_bf16 v[56:59], v[228:231], v[204:207], v[56:59]
    ds_read_b128 v[244:247], v248 offset:43008
    v_cvt_pk_bf16_f32 v197, v170, v171
    v_mfma_f32_16x16x32_bf16 v[28:31], v[232:235], v[200:203], v[28:31]
    v_exp_f32 v167, v167
    v_mfma_f32_16x16x32_bf16 v[60:63], v[232:235], v[204:207], v[60:63]
    ds_read_b128 v[228:231], v248 offset:44032
    s_waitcnt lgkmcnt(2)
    v_mfma_f32_16x16x32_bf16 v[176:179], v[236:239], v[64:67], v[208:211]
    v_exp_f32 v172, v172
    v_mfma_f32_16x16x32_bf16 v[184:187], v[236:239], v[80:83], v[212:215]
    ds_read_b128 v[232:235], v248 offset:45056
    v_cvt_pk_bf16_f32 v194, v164, v165
    v_mfma_f32_16x16x32_bf16 v[176:179], v[240:243], v[68:71], v[176:179]
    v_exp_f32 v173, v173
    v_mfma_f32_16x16x32_bf16 v[184:187], v[240:243], v[84:87], v[184:187]
    ds_read_b128 v[236:239], v248 offset:46080
    s_waitcnt lgkmcnt(2)
    v_mfma_f32_16x16x32_bf16 v[176:179], v[244:247], v[72:75], v[176:179]
    v_exp_f32 v174, v174
    v_mfma_f32_16x16x32_bf16 v[184:187], v[244:247], v[88:91], v[184:187]
    ds_read_b128 v[240:243], v248 offset:47104
    v_cvt_pk_bf16_f32 v195, v166, v167
    v_mfma_f32_16x16x32_bf16 v[176:179], v[228:231], v[76:79], v[176:179]
    v_exp_f32 v175, v175
    v_mfma_f32_16x16x32_bf16 v[184:187], v[228:231], v[92:95], v[184:187]
    ds_read_b128 v[244:247], v248 offset:48128
    s_waitcnt lgkmcnt(2)
    v_mfma_f32_16x16x32_bf16 v[180:183], v[232:235], v[64:67], v[208:211]
    v_cvt_pk_bf16_f32 v198, v172, v173
    v_cvt_pk_bf16_f32 v199, v174, v175
    v_mfma_f32_16x16x32_bf16 v[188:191], v[232:235], v[80:83], v[212:215]
    ds_read_b128 v[228:231], v250 offset:32768
    v_mfma_f32_16x16x32_bf16 v[180:183], v[236:239], v[68:71], v[180:183]
    v_exp_f32 v176, v176
    v_mfma_f32_16x16x32_bf16 v[188:191], v[236:239], v[84:87], v[188:191]
    ds_read_b128 v[232:235], v250 offset:33792
    s_waitcnt lgkmcnt(2)
    v_mfma_f32_16x16x32_bf16 v[180:183], v[240:243], v[72:75], v[180:183]
    v_exp_f32 v177, v177
    v_mfma_f32_16x16x32_bf16 v[188:191], v[240:243], v[88:91], v[188:191]
    ds_read_b128 v[236:239], v250 offset:34816
    v_cvt_pk_bf16_f32 v200, v176, v177
    v_mfma_f32_16x16x32_bf16 v[180:183], v[244:247], v[76:79], v[180:183]
    v_exp_f32 v178, v178
    v_mfma_f32_16x16x32_bf16 v[188:191], v[244:247], v[92:95], v[188:191]
    ds_read_b128 v[240:243], v250 offset:35840
    v_mfma_f32_16x16x32_bf16 v[216:219], v[224:227], v[192:195], v[216:219]
    v_exp_f32 v179, v179
    v_mfma_f32_16x16x32_bf16 v[220:223], v[224:227], v[196:199], v[220:223]
    s_waitcnt lgkmcnt(2)
    v_mfma_f32_16x16x32_bf16 v[0:3], v[228:231], v[192:195], v[0:3]
    v_exp_f32 v184, v184
    v_mfma_f32_16x16x32_bf16 v[32:35], v[228:231], v[196:199], v[32:35]
    ds_read_b128 v[244:247], v250 offset:36864
    v_cvt_pk_bf16_f32 v201, v178, v179
    v_mfma_f32_16x16x32_bf16 v[4:7], v[232:235], v[192:195], v[4:7]
    v_exp_f32 v185, v185
    v_mfma_f32_16x16x32_bf16 v[36:39], v[232:235], v[196:199], v[36:39]
    ds_read_b128 v[228:231], v250 offset:37888
    s_waitcnt lgkmcnt(2)
    v_mfma_f32_16x16x32_bf16 v[8:11], v[236:239], v[192:195], v[8:11]
    v_exp_f32 v186, v186
    v_mfma_f32_16x16x32_bf16 v[40:43], v[236:239], v[196:199], v[40:43]
    ds_read_b128 v[232:235], v250 offset:38912
    v_cvt_pk_bf16_f32 v204, v184, v185
    v_mfma_f32_16x16x32_bf16 v[12:15], v[240:243], v[192:195], v[12:15]
    v_exp_f32 v187, v187
    v_mfma_f32_16x16x32_bf16 v[44:47], v[240:243], v[196:199], v[44:47]
    ds_read_b128 v[236:239], v250 offset:39936
    s_waitcnt lgkmcnt(2)
    v_mfma_f32_16x16x32_bf16 v[16:19], v[244:247], v[192:195], v[16:19]
    v_exp_f32 v180, v180
    v_mfma_f32_16x16x32_bf16 v[48:51], v[244:247], v[196:199], v[48:51]
    ds_read_b128 v[240:243], v248 offset:49152
    v_cvt_pk_bf16_f32 v205, v186, v187
    v_mfma_f32_16x16x32_bf16 v[20:23], v[228:231], v[192:195], v[20:23]
    v_exp_f32 v181, v181
    v_mfma_f32_16x16x32_bf16 v[52:55], v[228:231], v[196:199], v[52:55]
    ds_read_b128 v[244:247], v248 offset:50176
    s_waitcnt lgkmcnt(2)
    v_mfma_f32_16x16x32_bf16 v[24:27], v[232:235], v[192:195], v[24:27]
    v_exp_f32 v182, v182
    v_mfma_f32_16x16x32_bf16 v[56:59], v[232:235], v[196:199], v[56:59]
    ds_read_b128 v[228:231], v248 offset:51200
    v_cvt_pk_bf16_f32 v202, v180, v181
    v_mfma_f32_16x16x32_bf16 v[28:31], v[236:239], v[192:195], v[28:31]
    v_exp_f32 v183, v183
    v_mfma_f32_16x16x32_bf16 v[60:63], v[236:239], v[196:199], v[60:63]
    ds_read_b128 v[232:235], v248 offset:52224
    s_waitcnt lgkmcnt(2)
    v_mfma_f32_16x16x32_bf16 v[160:163], v[240:243], v[64:67], v[208:211]
    v_exp_f32 v188, v188
    v_mfma_f32_16x16x32_bf16 v[168:171], v[240:243], v[80:83], v[212:215]
    ds_read_b128 v[236:239], v248 offset:53248
    v_cvt_pk_bf16_f32 v203, v182, v183
    v_mfma_f32_16x16x32_bf16 v[160:163], v[244:247], v[68:71], v[160:163]
    v_exp_f32 v189, v189
    v_mfma_f32_16x16x32_bf16 v[168:171], v[244:247], v[84:87], v[168:171]
    ds_read_b128 v[240:243], v248 offset:54272
    s_waitcnt lgkmcnt(2)
    v_mfma_f32_16x16x32_bf16 v[160:163], v[228:231], v[72:75], v[160:163]
    v_exp_f32 v190, v190
    v_mfma_f32_16x16x32_bf16 v[168:171], v[228:231], v[88:91], v[168:171]
    ds_read_b128 v[244:247], v248 offset:55296
    v_cvt_pk_bf16_f32 v206, v188, v189
    v_mfma_f32_16x16x32_bf16 v[160:163], v[232:235], v[76:79], v[160:163]
    v_exp_f32 v191, v191
    v_mfma_f32_16x16x32_bf16 v[168:171], v[232:235], v[92:95], v[168:171]
    ds_read_b128 v[228:231], v248 offset:56320
    s_waitcnt lgkmcnt(2)
    v_mfma_f32_16x16x32_bf16 v[164:167], v[236:239], v[64:67], v[208:211]
    v_cvt_pk_bf16_f32 v207, v190, v191
    v_mfma_f32_16x16x32_bf16 v[172:175], v[236:239], v[80:83], v[212:215]
    ds_read_b128 v[232:235], v250 offset:40960
    v_mfma_f32_16x16x32_bf16 v[164:167], v[240:243], v[68:71], v[164:167]
    v_exp_f32 v160, v160
    v_mfma_f32_16x16x32_bf16 v[172:175], v[240:243], v[84:87], v[172:175]
    ds_read_b128 v[236:239], v250 offset:41984
    s_waitcnt lgkmcnt(2)
    v_mfma_f32_16x16x32_bf16 v[164:167], v[244:247], v[72:75], v[164:167]
    v_exp_f32 v161, v161
    v_mfma_f32_16x16x32_bf16 v[172:175], v[244:247], v[88:91], v[172:175]
    ds_read_b128 v[240:243], v250 offset:43008
    v_cvt_pk_bf16_f32 v192, v160, v161
    v_mfma_f32_16x16x32_bf16 v[164:167], v[228:231], v[76:79], v[164:167]
    v_exp_f32 v162, v162
    v_mfma_f32_16x16x32_bf16 v[172:175], v[228:231], v[92:95], v[172:175]
    ds_read_b128 v[244:247], v250 offset:44032
    v_mfma_f32_16x16x32_bf16 v[216:219], v[224:227], v[200:203], v[216:219]
    v_exp_f32 v163, v163
    v_mfma_f32_16x16x32_bf16 v[220:223], v[224:227], v[204:207], v[220:223]
    s_waitcnt lgkmcnt(2)
    v_mfma_f32_16x16x32_bf16 v[0:3], v[232:235], v[200:203], v[0:3]
    v_exp_f32 v168, v168
    v_mfma_f32_16x16x32_bf16 v[32:35], v[232:235], v[204:207], v[32:35]
    ds_read_b128 v[228:231], v250 offset:45056
    v_cvt_pk_bf16_f32 v193, v162, v163
    v_mfma_f32_16x16x32_bf16 v[4:7], v[236:239], v[200:203], v[4:7]
    v_exp_f32 v169, v169
    v_mfma_f32_16x16x32_bf16 v[36:39], v[236:239], v[204:207], v[36:39]
    ds_read_b128 v[232:235], v250 offset:46080
    s_waitcnt lgkmcnt(2)
    v_mfma_f32_16x16x32_bf16 v[8:11], v[240:243], v[200:203], v[8:11]
    v_exp_f32 v170, v170
    v_mfma_f32_16x16x32_bf16 v[40:43], v[240:243], v[204:207], v[40:43]
    ds_read_b128 v[236:239], v250 offset:47104
    v_cvt_pk_bf16_f32 v196, v168, v169
    v_mfma_f32_16x16x32_bf16 v[12:15], v[244:247], v[200:203], v[12:15]
    v_exp_f32 v171, v171
    v_mfma_f32_16x16x32_bf16 v[44:47], v[244:247], v[204:207], v[44:47]
    ds_read_b128 v[240:243], v250 offset:48128
    s_waitcnt lgkmcnt(2)
    v_mfma_f32_16x16x32_bf16 v[16:19], v[228:231], v[200:203], v[16:19]
    v_exp_f32 v164, v164
    v_mfma_f32_16x16x32_bf16 v[48:51], v[228:231], v[204:207], v[48:51]
    ds_read_b128 v[244:247], v248 offset:57344
    v_cvt_pk_bf16_f32 v197, v170, v171
    v_mfma_f32_16x16x32_bf16 v[20:23], v[232:235], v[200:203], v[20:23]
    v_exp_f32 v165, v165
    v_mfma_f32_16x16x32_bf16 v[52:55], v[232:235], v[204:207], v[52:55]
    ds_read_b128 v[228:231], v248 offset:58368
    s_waitcnt lgkmcnt(2)
    v_mfma_f32_16x16x32_bf16 v[24:27], v[236:239], v[200:203], v[24:27]
    v_exp_f32 v166, v166
    v_mfma_f32_16x16x32_bf16 v[56:59], v[236:239], v[204:207], v[56:59]
    ds_read_b128 v[232:235], v248 offset:59392
    v_cvt_pk_bf16_f32 v194, v164, v165
    v_mfma_f32_16x16x32_bf16 v[28:31], v[240:243], v[200:203], v[28:31]
    v_exp_f32 v167, v167
    v_mfma_f32_16x16x32_bf16 v[60:63], v[240:243], v[204:207], v[60:63]
    ds_read_b128 v[236:239], v248 offset:60416
    s_waitcnt lgkmcnt(2)
    v_mfma_f32_16x16x32_bf16 v[176:179], v[244:247], v[64:67], v[208:211]
    v_exp_f32 v172, v172
    v_mfma_f32_16x16x32_bf16 v[184:187], v[244:247], v[80:83], v[212:215]
    ds_read_b128 v[240:243], v248 offset:61440
    v_cvt_pk_bf16_f32 v195, v166, v167
    v_mfma_f32_16x16x32_bf16 v[176:179], v[228:231], v[68:71], v[176:179]
    v_exp_f32 v173, v173
    v_mfma_f32_16x16x32_bf16 v[184:187], v[228:231], v[84:87], v[184:187]
    ds_read_b128 v[244:247], v248 offset:62464
    s_waitcnt lgkmcnt(2)
    v_mfma_f32_16x16x32_bf16 v[176:179], v[232:235], v[72:75], v[176:179]
    v_exp_f32 v174, v174
    v_mfma_f32_16x16x32_bf16 v[184:187], v[232:235], v[88:91], v[184:187]
    ds_read_b128 v[228:231], v248 offset:63488
    v_cvt_pk_bf16_f32 v198, v172, v173
    v_mfma_f32_16x16x32_bf16 v[176:179], v[236:239], v[76:79], v[176:179]
    v_exp_f32 v175, v175
    v_mfma_f32_16x16x32_bf16 v[184:187], v[236:239], v[92:95], v[184:187]
    ds_read_b128 v[232:235], v248 offset:64512
    s_waitcnt lgkmcnt(2)
    v_mfma_f32_16x16x32_bf16 v[180:183], v[240:243], v[64:67], v[208:211]
    v_cvt_pk_bf16_f32 v199, v174, v175
    v_mfma_f32_16x16x32_bf16 v[188:191], v[240:243], v[80:83], v[212:215]
    ds_read_b128 v[236:239], v250 offset:49152
    v_mfma_f32_16x16x32_bf16 v[180:183], v[244:247], v[68:71], v[180:183]
    v_exp_f32 v176, v176
    v_mfma_f32_16x16x32_bf16 v[188:191], v[244:247], v[84:87], v[188:191]
    ds_read_b128 v[240:243], v250 offset:50176
    s_waitcnt lgkmcnt(2)
    v_mfma_f32_16x16x32_bf16 v[180:183], v[228:231], v[72:75], v[180:183]
    v_exp_f32 v177, v177
    v_mfma_f32_16x16x32_bf16 v[188:191], v[228:231], v[88:91], v[188:191]
    ds_read_b128 v[244:247], v250 offset:51200
    v_cvt_pk_bf16_f32 v200, v176, v177
    v_mfma_f32_16x16x32_bf16 v[180:183], v[232:235], v[76:79], v[180:183]
    v_exp_f32 v178, v178
    v_mfma_f32_16x16x32_bf16 v[188:191], v[232:235], v[92:95], v[188:191]
    ds_read_b128 v[228:231], v250 offset:52224
    v_mfma_f32_16x16x32_bf16 v[216:219], v[224:227], v[192:195], v[216:219]
    v_exp_f32 v179, v179
    v_mfma_f32_16x16x32_bf16 v[220:223], v[224:227], v[196:199], v[220:223]
    s_waitcnt lgkmcnt(2)
    v_mfma_f32_16x16x32_bf16 v[0:3], v[236:239], v[192:195], v[0:3]
    v_exp_f32 v184, v184
    v_mfma_f32_16x16x32_bf16 v[32:35], v[236:239], v[196:199], v[32:35]
    ds_read_b128 v[232:235], v250 offset:53248
    v_cvt_pk_bf16_f32 v201, v178, v179
    v_mfma_f32_16x16x32_bf16 v[4:7], v[240:243], v[192:195], v[4:7]
    v_exp_f32 v185, v185
    v_mfma_f32_16x16x32_bf16 v[36:39], v[240:243], v[196:199], v[36:39]
    ds_read_b128 v[236:239], v250 offset:54272
    s_waitcnt lgkmcnt(2)
    v_mfma_f32_16x16x32_bf16 v[8:11], v[244:247], v[192:195], v[8:11]
    v_exp_f32 v186, v186
    v_mfma_f32_16x16x32_bf16 v[40:43], v[244:247], v[196:199], v[40:43]
    ds_read_b128 v[240:243], v250 offset:55296
    v_cvt_pk_bf16_f32 v204, v184, v185
    v_mfma_f32_16x16x32_bf16 v[12:15], v[228:231], v[192:195], v[12:15]
    v_exp_f32 v187, v187
    v_mfma_f32_16x16x32_bf16 v[44:47], v[228:231], v[196:199], v[44:47]
    ds_read_b128 v[244:247], v250 offset:56320
    s_waitcnt lgkmcnt(2)
    v_mfma_f32_16x16x32_bf16 v[16:19], v[232:235], v[192:195], v[16:19]
    v_exp_f32 v180, v180
    v_mfma_f32_16x16x32_bf16 v[48:51], v[232:235], v[196:199], v[48:51]
    ds_read_b128 v[228:231], v249 offset:0
    v_cvt_pk_bf16_f32 v205, v186, v187
    v_mfma_f32_16x16x32_bf16 v[20:23], v[236:239], v[192:195], v[20:23]
    v_exp_f32 v181, v181
    v_mfma_f32_16x16x32_bf16 v[52:55], v[236:239], v[196:199], v[52:55]
    ds_read_b128 v[232:235], v249 offset:1024
    s_waitcnt lgkmcnt(2)
    v_mfma_f32_16x16x32_bf16 v[24:27], v[240:243], v[192:195], v[24:27]
    v_exp_f32 v182, v182
    v_mfma_f32_16x16x32_bf16 v[56:59], v[240:243], v[196:199], v[56:59]
    ds_read_b128 v[236:239], v249 offset:2048
    v_cvt_pk_bf16_f32 v202, v180, v181
    v_mfma_f32_16x16x32_bf16 v[28:31], v[244:247], v[192:195], v[28:31]
    v_exp_f32 v183, v183
    v_mfma_f32_16x16x32_bf16 v[60:63], v[244:247], v[196:199], v[60:63]
    ds_read_b128 v[240:243], v249 offset:3072
    s_waitcnt lgkmcnt(2)
    v_mfma_f32_16x16x32_bf16 v[160:163], v[228:231], v[64:67], v[208:211]
    v_exp_f32 v188, v188
    v_mfma_f32_16x16x32_bf16 v[168:171], v[228:231], v[80:83], v[212:215]
    ds_read_b128 v[244:247], v249 offset:4096
    v_cvt_pk_bf16_f32 v203, v182, v183
    v_mfma_f32_16x16x32_bf16 v[160:163], v[232:235], v[68:71], v[160:163]
    v_exp_f32 v189, v189
    v_mfma_f32_16x16x32_bf16 v[168:171], v[232:235], v[84:87], v[168:171]
    ds_read_b128 v[228:231], v249 offset:5120
    s_waitcnt lgkmcnt(2)
    v_mfma_f32_16x16x32_bf16 v[160:163], v[236:239], v[72:75], v[160:163]
    v_exp_f32 v190, v190
    v_mfma_f32_16x16x32_bf16 v[168:171], v[236:239], v[88:91], v[168:171]
    ds_read_b128 v[232:235], v249 offset:6144
    v_cvt_pk_bf16_f32 v206, v188, v189
    v_mfma_f32_16x16x32_bf16 v[160:163], v[240:243], v[76:79], v[160:163]
    v_exp_f32 v191, v191
    v_mfma_f32_16x16x32_bf16 v[168:171], v[240:243], v[92:95], v[168:171]
    ds_read_b128 v[236:239], v249 offset:7168
    s_waitcnt lgkmcnt(2)
    v_mfma_f32_16x16x32_bf16 v[164:167], v[244:247], v[64:67], v[208:211]
    v_cvt_pk_bf16_f32 v207, v190, v191
    v_mfma_f32_16x16x32_bf16 v[172:175], v[244:247], v[80:83], v[212:215]
    ds_read_b128 v[240:243], v250 offset:57344
    v_mfma_f32_16x16x32_bf16 v[164:167], v[228:231], v[68:71], v[164:167]
    v_exp_f32 v160, v160
    v_mfma_f32_16x16x32_bf16 v[172:175], v[228:231], v[84:87], v[172:175]
    ds_read_b128 v[244:247], v250 offset:58368
    s_waitcnt lgkmcnt(2)
    v_mfma_f32_16x16x32_bf16 v[164:167], v[232:235], v[72:75], v[164:167]
    v_exp_f32 v161, v161
    v_mfma_f32_16x16x32_bf16 v[172:175], v[232:235], v[88:91], v[172:175]
    ds_read_b128 v[228:231], v250 offset:59392
    v_cvt_pk_bf16_f32 v192, v160, v161
    v_mfma_f32_16x16x32_bf16 v[164:167], v[236:239], v[76:79], v[164:167]
    v_exp_f32 v162, v162
    v_mfma_f32_16x16x32_bf16 v[172:175], v[236:239], v[92:95], v[172:175]
    ds_read_b128 v[232:235], v250 offset:60416
    v_mfma_f32_16x16x32_bf16 v[216:219], v[224:227], v[200:203], v[216:219]
    v_exp_f32 v163, v163
    v_mfma_f32_16x16x32_bf16 v[220:223], v[224:227], v[204:207], v[220:223]
    s_waitcnt lgkmcnt(2)
    v_mfma_f32_16x16x32_bf16 v[0:3], v[240:243], v[200:203], v[0:3]
    v_exp_f32 v168, v168
    v_mfma_f32_16x16x32_bf16 v[32:35], v[240:243], v[204:207], v[32:35]
    ds_read_b128 v[236:239], v250 offset:61440
    v_cvt_pk_bf16_f32 v193, v162, v163
    v_mfma_f32_16x16x32_bf16 v[4:7], v[244:247], v[200:203], v[4:7]
    v_exp_f32 v169, v169
    v_mfma_f32_16x16x32_bf16 v[36:39], v[244:247], v[204:207], v[36:39]
    ds_read_b128 v[240:243], v250 offset:62464
    s_waitcnt lgkmcnt(2)
    v_mfma_f32_16x16x32_bf16 v[8:11], v[228:231], v[200:203], v[8:11]
    v_exp_f32 v170, v170
    v_mfma_f32_16x16x32_bf16 v[40:43], v[228:231], v[204:207], v[40:43]
    ds_read_b128 v[244:247], v250 offset:63488
    v_cvt_pk_bf16_f32 v196, v168, v169
    v_mfma_f32_16x16x32_bf16 v[12:15], v[232:235], v[200:203], v[12:15]
    v_exp_f32 v171, v171
    v_mfma_f32_16x16x32_bf16 v[44:47], v[232:235], v[204:207], v[44:47]
    ds_read_b128 v[228:231], v250 offset:64512
    s_waitcnt lgkmcnt(2)
    v_mfma_f32_16x16x32_bf16 v[16:19], v[236:239], v[200:203], v[16:19]
    v_exp_f32 v164, v164
    v_mfma_f32_16x16x32_bf16 v[48:51], v[236:239], v[204:207], v[48:51]
    ds_read_b128 v[232:235], v249 offset:8192
    v_cvt_pk_bf16_f32 v197, v170, v171
    v_mfma_f32_16x16x32_bf16 v[20:23], v[240:243], v[200:203], v[20:23]
    v_exp_f32 v165, v165
    v_mfma_f32_16x16x32_bf16 v[52:55], v[240:243], v[204:207], v[52:55]
    ds_read_b128 v[236:239], v249 offset:9216
    s_waitcnt lgkmcnt(2)
    v_mfma_f32_16x16x32_bf16 v[24:27], v[244:247], v[200:203], v[24:27]
    v_exp_f32 v166, v166
    v_mfma_f32_16x16x32_bf16 v[56:59], v[244:247], v[204:207], v[56:59]
    ds_read_b128 v[240:243], v249 offset:10240
    v_cvt_pk_bf16_f32 v194, v164, v165
    v_mfma_f32_16x16x32_bf16 v[28:31], v[228:231], v[200:203], v[28:31]
    v_exp_f32 v167, v167
    v_mfma_f32_16x16x32_bf16 v[60:63], v[228:231], v[204:207], v[60:63]
    ds_read_b128 v[244:247], v249 offset:11264
    s_waitcnt lgkmcnt(2)
    v_mfma_f32_16x16x32_bf16 v[176:179], v[232:235], v[64:67], v[208:211]
    v_exp_f32 v172, v172
    v_cvt_pk_bf16_f32 v195, v166, v167
    v_mfma_f32_16x16x32_bf16 v[184:187], v[232:235], v[80:83], v[212:215]
    ds_read_b128 v[228:231], v249 offset:12288
    v_exp_f32 v173, v173
    v_mfma_f32_16x16x32_bf16 v[176:179], v[236:239], v[68:71], v[176:179]
    v_exp_f32 v174, v174
    v_cvt_pk_bf16_f32 v198, v172, v173
    v_mfma_f32_16x16x32_bf16 v[184:187], v[236:239], v[84:87], v[184:187]
    ds_read_b128 v[232:235], v249 offset:13312
    s_waitcnt lgkmcnt(2)
    v_mfma_f32_16x16x32_bf16 v[176:179], v[240:243], v[72:75], v[176:179]
    v_exp_f32 v175, v175
    v_mfma_f32_16x16x32_bf16 v[184:187], v[240:243], v[88:91], v[184:187]
    ds_read_b128 v[236:239], v249 offset:14336
    v_cvt_pk_bf16_f32 v199, v174, v175
    v_mfma_f32_16x16x32_bf16 v[176:179], v[244:247], v[76:79], v[176:179]
    v_mfma_f32_16x16x32_bf16 v[184:187], v[244:247], v[92:95], v[184:187]
    ds_read_b128 v[240:243], v249 offset:15360
    s_waitcnt lgkmcnt(2)
    v_mfma_f32_16x16x32_bf16 v[180:183], v[228:231], v[64:67], v[208:211]
    v_mfma_f32_16x16x32_bf16 v[188:191], v[228:231], v[80:83], v[212:215]
    ds_read_b128 v[244:247], v251 offset:0
    v_mfma_f32_16x16x32_bf16 v[180:183], v[232:235], v[68:71], v[180:183]
    s_nop 0
    v_exp_f32 v176, v176
    v_mfma_f32_16x16x32_bf16 v[188:191], v[232:235], v[84:87], v[188:191]
    ds_read_b128 v[228:231], v251 offset:1024
    s_waitcnt lgkmcnt(2)
    v_mfma_f32_16x16x32_bf16 v[180:183], v[236:239], v[72:75], v[180:183]
    v_exp_f32 v177, v177
    v_mfma_f32_16x16x32_bf16 v[188:191], v[236:239], v[88:91], v[188:191]
    ds_read_b128 v[232:235], v251 offset:2048
    v_cvt_pk_bf16_f32 v200, v176, v177
    v_mfma_f32_16x16x32_bf16 v[180:183], v[240:243], v[76:79], v[180:183]
    v_exp_f32 v178, v178
    v_mfma_f32_16x16x32_bf16 v[188:191], v[240:243], v[92:95], v[188:191]
    ds_read_b128 v[236:239], v251 offset:3072
    v_mfma_f32_16x16x32_bf16 v[216:219], v[224:227], v[192:195], v[216:219]
    v_exp_f32 v179, v179
    v_mfma_f32_16x16x32_bf16 v[220:223], v[224:227], v[196:199], v[220:223]
    s_waitcnt lgkmcnt(2)
    v_mfma_f32_16x16x32_bf16 v[0:3], v[244:247], v[192:195], v[0:3]
    v_exp_f32 v184, v184
    v_cvt_pk_bf16_f32 v201, v178, v179
    v_mfma_f32_16x16x32_bf16 v[32:35], v[244:247], v[196:199], v[32:35]
    ds_read_b128 v[240:243], v251 offset:4096
    v_exp_f32 v185, v185
    v_mfma_f32_16x16x32_bf16 v[4:7], v[228:231], v[192:195], v[4:7]
    v_exp_f32 v186, v186
    v_cvt_pk_bf16_f32 v204, v184, v185
    v_mfma_f32_16x16x32_bf16 v[36:39], v[228:231], v[196:199], v[36:39]
    ds_read_b128 v[244:247], v251 offset:5120
    s_waitcnt lgkmcnt(2)
    v_mfma_f32_16x16x32_bf16 v[8:11], v[232:235], v[192:195], v[8:11]
    v_exp_f32 v187, v187
    v_mfma_f32_16x16x32_bf16 v[40:43], v[232:235], v[196:199], v[40:43]
    ds_read_b128 v[228:231], v251 offset:6144
    v_cvt_pk_bf16_f32 v205, v186, v187
    v_mfma_f32_16x16x32_bf16 v[12:15], v[236:239], v[192:195], v[12:15]
    v_exp_f32 v180, v180
    v_mfma_f32_16x16x32_bf16 v[44:47], v[236:239], v[196:199], v[44:47]
    ds_read_b128 v[232:235], v251 offset:7168
    s_waitcnt lgkmcnt(2)
    v_mfma_f32_16x16x32_bf16 v[16:19], v[240:243], v[192:195], v[16:19]
    v_exp_f32 v181, v181
    v_exp_f32 v182, v182
    v_mfma_f32_16x16x32_bf16 v[48:51], v[240:243], v[196:199], v[48:51]
    ds_read_b128 v[236:239], v251 offset:8192
    v_cvt_pk_bf16_f32 v202, v180, v181
    v_mfma_f32_16x16x32_bf16 v[20:23], v[244:247], v[192:195], v[20:23]
    v_exp_f32 v183, v183
    v_exp_f32 v188, v188
    v_mfma_f32_16x16x32_bf16 v[52:55], v[244:247], v[196:199], v[52:55]
    ds_read_b128 v[240:243], v251 offset:9216
    v_cvt_pk_bf16_f32 v203, v182, v183
    s_waitcnt lgkmcnt(2)
    v_mfma_f32_16x16x32_bf16 v[24:27], v[228:231], v[192:195], v[24:27]
    v_exp_f32 v189, v189
    v_mfma_f32_16x16x32_bf16 v[56:59], v[228:231], v[196:199], v[56:59]
    ds_read_b128 v[244:247], v251 offset:10240
    v_cvt_pk_bf16_f32 v206, v188, v189
    v_exp_f32 v190, v190
    v_mfma_f32_16x16x32_bf16 v[28:31], v[232:235], v[192:195], v[28:31]
    v_exp_f32 v191, v191
    v_mfma_f32_16x16x32_bf16 v[60:63], v[232:235], v[196:199], v[60:63]
    ds_read_b128 v[228:231], v251 offset:11264
    v_cvt_pk_bf16_f32 v207, v190, v191
    v_mfma_f32_16x16x32_bf16 v[216:219], v[224:227], v[200:203], v[216:219]
    s_nop 0
    v_mfma_f32_16x16x32_bf16 v[220:223], v[224:227], v[204:207], v[220:223]
    s_waitcnt lgkmcnt(2)
    v_mfma_f32_16x16x32_bf16 v[0:3], v[236:239], v[200:203], v[0:3]
    v_mfma_f32_16x16x32_bf16 v[32:35], v[236:239], v[204:207], v[32:35]
    ds_read_b128 v[232:235], v251 offset:12288
    v_mfma_f32_16x16x32_bf16 v[4:7], v[240:243], v[200:203], v[4:7]
    v_mfma_f32_16x16x32_bf16 v[36:39], v[240:243], v[204:207], v[36:39]
    ds_read_b128 v[236:239], v251 offset:13312
    s_waitcnt lgkmcnt(2)
    v_mfma_f32_16x16x32_bf16 v[8:11], v[244:247], v[200:203], v[8:11]
    v_mfma_f32_16x16x32_bf16 v[40:43], v[244:247], v[204:207], v[40:43]
    ds_read_b128 v[240:243], v251 offset:14336
    v_mfma_f32_16x16x32_bf16 v[12:15], v[228:231], v[200:203], v[12:15]
    v_mfma_f32_16x16x32_bf16 v[44:47], v[228:231], v[204:207], v[44:47]
    ds_read_b128 v[244:247], v251 offset:15360
    s_waitcnt lgkmcnt(2)
    v_mfma_f32_16x16x32_bf16 v[16:19], v[232:235], v[200:203], v[16:19]
    v_mfma_f32_16x16x32_bf16 v[48:51], v[232:235], v[204:207], v[48:51]
    v_mfma_f32_16x16x32_bf16 v[20:23], v[236:239], v[200:203], v[20:23]
    v_mfma_f32_16x16x32_bf16 v[52:55], v[236:239], v[204:207], v[52:55]
    s_waitcnt lgkmcnt(0)
    v_mfma_f32_16x16x32_bf16 v[24:27], v[240:243], v[200:203], v[24:27]
    v_mfma_f32_16x16x32_bf16 v[56:59], v[240:243], v[204:207], v[56:59]
    v_mfma_f32_16x16x32_bf16 v[28:31], v[244:247], v[200:203], v[28:31]
    v_mfma_f32_16x16x32_bf16 v[60:63], v[244:247], v[204:207], v[60:63]
    s_setprio 0
    v_cmp_gt_f32 vcc, s29, v216
    v_cmp_gt_f32 s[38:39], s29, v220
    s_nop 0
    s_and_b64 vcc, vcc, s[38:39]
    s_cmp_eq_u64 vcc, -1
    s_cbranch_scc0 L_fix0
    s_branch L_ok0
L_ok2:
    v_rcp_f32 v253, v216
    v_rcp_f32 v254, v220
    v_mul_f32 v0, v0, v253
    v_mul_f32 v1, v1, v253
    v_mul_f32 v2, v2, v253
    v_mul_f32 v3, v3, v253
    v_mul_f32 v4, v4, v253
    v_mul_f32 v5, v5, v253
    v_mul_f32 v6, v6, v253
    v_mul_f32 v7, v7, v253
    v_cvt_pk_bf16_f32 v128, v0, v1
    v_cvt_pk_bf16_f32 v129, v2, v3
    v_cvt_pk_bf16_f32 v130, v4, v5
    v_cvt_pk_bf16_f32 v131, v6, v7
    buffer_store_dwordx4 v[128:131], v252, s[16:19], s25 offen offset:0 sc1
    v_mul_f32 v8, v8, v253
    v_mul_f32 v9, v9, v253
    v_mul_f32 v10, v10, v253
    v_mul_f32 v11, v11, v253
    v_mul_f32 v12, v12, v253
    v_mul_f32 v13, v13, v253
    v_mul_f32 v14, v14, v253
    v_mul_f32 v15, v15, v253
    v_cvt_pk_bf16_f32 v132, v8, v9
    v_cvt_pk_bf16_f32 v133, v10, v11
    v_cvt_pk_bf16_f32 v134, v12, v13
    v_cvt_pk_bf16_f32 v135, v14, v15
    buffer_store_dwordx4 v[132:135], v252, s[16:19], s25 offen offset:64 sc1
    v_mul_f32 v32, v32, v254
    v_mul_f32 v33, v33, v254
    v_mul_f32 v34, v34, v254
    v_mul_f32 v35, v35, v254
    v_mul_f32 v36, v36, v254
    v_mul_f32 v37, v37, v254
    v_mul_f32 v38, v38, v254
    v_mul_f32 v39, v39, v254
    v_cvt_pk_bf16_f32 v144, v32, v33
    v_cvt_pk_bf16_f32 v145, v34, v35
    v_cvt_pk_bf16_f32 v146, v36, v37
    v_cvt_pk_bf16_f32 v147, v38, v39
    buffer_store_dwordx4 v[144:147], v252, s[16:19], s26 offen offset:0 sc1
    v_mul_f32 v40, v40, v254
    v_mul_f32 v41, v41, v254
    v_mul_f32 v42, v42, v254
    v_mul_f32 v43, v43, v254
    v_mul_f32 v44, v44, v254
    v_mul_f32 v45, v45, v254
    v_mul_f32 v46, v46, v254
    v_mul_f32 v47, v47, v254
    v_cvt_pk_bf16_f32 v148, v40, v41
    v_cvt_pk_bf16_f32 v149, v42, v43
    v_cvt_pk_bf16_f32 v150, v44, v45
    v_cvt_pk_bf16_f32 v151, v46, v47
    buffer_store_dwordx4 v[148:151], v252, s[16:19], s26 offen offset:64 sc1
    v_mul_f32 v16, v16, v253
    v_mul_f32 v17, v17, v253
    v_mul_f32 v18, v18, v253
    v_mul_f32 v19, v19, v253
    v_mul_f32 v20, v20, v253
    v_mul_f32 v21, v21, v253
    v_mul_f32 v22, v22, v253
    v_mul_f32 v23, v23, v253
    v_cvt_pk_bf16_f32 v136, v16, v17
    v_cvt_pk_bf16_f32 v137, v18, v19
    v_cvt_pk_bf16_f32 v138, v20, v21
    v_cvt_pk_bf16_f32 v139, v22, v23
    buffer_store_dwordx4 v[136:139], v252, s[16:19], s25 offen offset:128 sc1
    v_mul_f32 v24, v24, v253
    v_mul_f32 v25, v25, v253
    v_mul_f32 v26, v26, v253
    v_mul_f32 v27, v27, v253
    v_mul_f32 v28, v28, v253
    v_mul_f32 v29, v29, v253
    v_mul_f32 v30, v30, v253
    v_mul_f32 v31, v31, v253
    v_cvt_pk_bf16_f32 v140, v24, v25
    v_cvt_pk_bf16_f32 v141, v26, v27
    v_cvt_pk_bf16_f32 v142, v28, v29
    v_cvt_pk_bf16_f32 v143, v30, v31
    buffer_store_dwordx4 v[140:143], v252, s[16:19], s25 offen offset:192 sc1
    v_mul_f32 v48, v48, v254
    v_mul_f32 v49, v49, v254
    v_mul_f32 v50, v50, v254
    v_mul_f32 v51, v51, v254
    v_mul_f32 v52, v52, v254
    v_mul_f32 v53, v53, v254
    v_mul_f32 v54, v54, v254
    v_mul_f32 v55, v55, v254
    v_cvt_pk_bf16_f32 v152, v48, v49
    v_cvt_pk_bf16_f32 v153, v50, v51
    v_cvt_pk_bf16_f32 v154, v52, v53
    v_cvt_pk_bf16_f32 v155, v54, v55
    buffer_store_dwordx4 v[152:155], v252, s[16:19], s26 offen offset:128 sc1
    v_mul_f32 v56, v56, v254
    v_mul_f32 v57, v57, v254
    v_mul_f32 v58, v58, v254
    v_mul_f32 v59, v59, v254
    v_mul_f32 v60, v60, v254
    v_mul_f32 v61, v61, v254
    v_mul_f32 v62, v62, v254
    v_mul_f32 v63, v63, v254
    v_cvt_pk_bf16_f32 v156, v56, v57
    v_cvt_pk_bf16_f32 v157, v58, v59
    v_cvt_pk_bf16_f32 v158, v60, v61
    v_cvt_pk_bf16_f32 v159, v62, v63
    buffer_store_dwordx4 v[156:159], v252, s[16:19], s26 offen offset:192 sc1
    s_branch L_done
L_fix0:
    s_waitcnt vmcnt(0) lgkmcnt(0)
    s_nop 7
    s_call_b64 s[40:41], L_slow
    s_branch L_ok0
L_fix1:
    s_waitcnt vmcnt(0) lgkmcnt(0)
    s_nop 7
    v_mov_b32 v64, v96
    v_mov_b32 v65, v97
    v_mov_b32 v66, v98
    v_mov_b32 v67, v99
    v_mov_b32 v68, v100
    v_mov_b32 v69, v101
    v_mov_b32 v70, v102
    v_mov_b32 v71, v103
    v_mov_b32 v72, v104
    v_mov_b32 v73, v105
    v_mov_b32 v74, v106
    v_mov_b32 v75, v107
    v_mov_b32 v76, v108
    v_mov_b32 v77, v109
    v_mov_b32 v78, v110
    v_mov_b32 v79, v111
    v_mov_b32 v80, v112
    v_mov_b32 v81, v113
    v_mov_b32 v82, v114
    v_mov_b32 v83, v115
    v_mov_b32 v84, v116
    v_mov_b32 v85, v117
    v_mov_b32 v86, v118
    v_mov_b32 v87, v119
    v_mov_b32 v88, v120
    v_mov_b32 v89, v121
    v_mov_b32 v90, v122
    v_mov_b32 v91, v123
    v_mov_b32 v92, v124
    v_mov_b32 v93, v125
    v_mov_b32 v94, v126
    v_mov_b32 v95, v127
    s_call_b64 s[40:41], L_slow
    s_branch L_ok1
L_fix2:
    s_waitcnt vmcnt(0) lgkmcnt(0)
    s_nop 7
    v_mov_b32 v64, v128
    v_mov_b32 v65, v129
    v_mov_b32 v66, v130
    v_mov_b32 v67, v131
    v_mov_b32 v68, v132
    v_mov_b32 v69, v133
    v_mov_b32 v70, v134
    v_mov_b32 v71, v135
    v_mov_b32 v72, v136
    v_mov_b32 v73, v137
    v_mov_b32 v74, v138
    v_mov_b32 v75, v139
    v_mov_b32 v76, v140
    v_mov_b32 v77, v141
    v_mov_b32 v78, v142
    v_mov_b32 v79, v143
    v_mov_b32 v80, v144
    v_mov_b32 v81, v145
    v_mov_b32 v82, v146
    v_mov_b32 v83, v147
    v_mov_b32 v84, v148
    v_mov_b32 v85, v149
    v_mov_b32 v86, v150
    v_mov_b32 v87, v151
    v_mov_b32 v88, v152
    v_mov_b32 v89, v153
    v_mov_b32 v90, v154
    v_mov_b32 v91, v155
    v_mov_b32 v92, v156
    v_mov_b32 v93, v157
    v_mov_b32 v94, v158
    v_mov_b32 v95, v159
    s_call_b64 s[40:41], L_slow
    s_branch L_ok2
L_slow:
    s_nop 15
    v_mov_b32 v208, 0xff800000
    v_mov_b32 v212, 0xff800000
    s_mov_b32 s30, 0
L_slow1:
    v_add_u32 v253, s30, v248
    ds_read_b128 v[228:231], v253 offset:0
    ds_read_b128 v[232:235], v253 offset:1024
    ds_read_b128 v[236:239], v253 offset:2048
    ds_read_b128 v[240:243], v253 offset:3072
    ds_read_b128 v[176:179], v253 offset:4096
    ds_read_b128 v[180:183], v253 offset:5120
    ds_read_b128 v[184:187], v253 offset:6144
    ds_read_b128 v[188:191], v253 offset:7168
    s_waitcnt lgkmcnt(0)
    v_mfma_f32_16x16x32_bf16 v[160:163], v[228:231], v[64:67], 0
    v_mfma_f32_16x16x32_bf16 v[168:171], v[228:231], v[80:83], 0
    v_mfma_f32_16x16x32_bf16 v[160:163], v[232:235], v[68:71], v[160:163]
    v_mfma_f32_16x16x32_bf16 v[168:171], v[232:235], v[84:87], v[168:171]
    v_mfma_f32_16x16x32_bf16 v[160:163], v[236:239], v[72:75], v[160:163]
    v_mfma_f32_16x16x32_bf16 v[168:171], v[236:239], v[88:91], v[168:171]
    v_mfma_f32_16x16x32_bf16 v[160:163], v[240:243], v[76:79], v[160:163]
    v_mfma_f32_16x16x32_bf16 v[168:171], v[240:243], v[92:95], v[168:171]
    v_mfma_f32_16x16x32_bf16 v[164:167], v[176:179], v[64:67], 0
    v_mfma_f32_16x16x32_bf16 v[172:175], v[176:179], v[80:83], 0
    v_mfma_f32_16x16x32_bf16 v[164:167], v[180:183], v[68:71], v[164:167]
    v_mfma_f32_16x16x32_bf16 v[172:175], v[180:183], v[84:87], v[172:175]
    v_mfma_f32_16x16x32_bf16 v[164:167], v[184:187], v[72:75], v[164:167]
    v_mfma_f32_16x16x32_bf16 v[172:175], v[184:187], v[88:91], v[172:175]
    v_mfma_f32_16x16x32_bf16 v[164:167], v[188:191], v[76:79], v[164:167]
    v_mfma_f32_16x16x32_bf16 v[172:175], v[188:191], v[92:95], v[172:175]
    s_nop 15
    v_max3_f32 v208, v160, v161, v208
    v_max3_f32 v208, v162, v163, v208
    v_max3_f32 v208, v164, v165, v208
    v_max3_f32 v208, v166, v167, v208
    v_max3_f32 v212, v168, v169, v212
    v_max3_f32 v212, v170, v171, v212
    v_max3_f32 v212, v172, v173, v212
    v_max3_f32 v212, v174, v175, v212
    s_add_u32 s30, s30, 8192
    s_cmp_lt_u32 s30, 81920
    s_cbranch_scc1 L_slow1
    s_nop 1
    v_permlane16_swap_b32 v208, v212
    s_nop 1
    v_max_f32 v208, v208, v212
    s_nop 1
    v_mov_b32 v212, v208
    s_nop 1
    v_permlane32_swap_b32 v208, v212
    s_nop 1
    v_max_f32 v208, v208, v212
    s_nop 1
    v_mov_b32 v212, v208
    s_nop 1
    v_permlane16_swap_b32 v208, v212
    v_sub_f32 v209, 0, v208
    v_sub_f32 v210, 0, v208
    v_sub_f32 v211, 0, v208
    v_sub_f32 v208, 0, v208
    v_sub_f32 v213, 0, v212
    v_sub_f32 v214, 0, v212
    v_sub_f32 v215, 0, v212
    v_sub_f32 v212, 0, v212
    v_mov_b32 v0, 0
    v_mov_b32 v1, 0
    v_mov_b32 v2, 0
    v_mov_b32 v3, 0
    v_mov_b32 v4, 0
    v_mov_b32 v5, 0
    v_mov_b32 v6, 0
    v_mov_b32 v7, 0
    v_mov_b32 v8, 0
    v_mov_b32 v9, 0
    v_mov_b32 v10, 0
    v_mov_b32 v11, 0
    v_mov_b32 v12, 0
    v_mov_b32 v13, 0
    v_mov_b32 v14, 0
    v_mov_b32 v15, 0
    v_mov_b32 v16, 0
    v_mov_b32 v17, 0
    v_mov_b32 v18, 0
    v_mov_b32 v19, 0
    v_mov_b32 v20, 0
    v_mov_b32 v21, 0
    v_mov_b32 v22, 0
    v_mov_b32 v23, 0
    v_mov_b32 v24, 0
    v_mov_b32 v25, 0
    v_mov_b32 v26, 0
    v_mov_b32 v27, 0
    v_mov_b32 v28, 0
    v_mov_b32 v29, 0
    v_mov_b32 v30, 0
    v_mov_b32 v31, 0
    v_mov_b32 v32, 0
    v_mov_b32 v33, 0
    v_mov_b32 v34, 0
    v_mov_b32 v35, 0
    v_mov_b32 v36, 0
    v_mov_b32 v37, 0
    v_mov_b32 v38, 0
    v_mov_b32 v39, 0
    v_mov_b32 v40, 0
    v_mov_b32 v41, 0
    v_mov_b32 v42, 0
    v_mov_b32 v43, 0
    v_mov_b32 v44, 0
    v_mov_b32 v45, 0
    v_mov_b32 v46, 0
    v_mov_b32 v47, 0
    v_mov_b32 v48, 0
    v_mov_b32 v49, 0
    v_mov_b32 v50, 0
    v_mov_b32 v51, 0
    v_mov_b32 v52, 0
    v_mov_b32 v53, 0
    v_mov_b32 v54, 0
    v_mov_b32 v55, 0
    v_mov_b32 v56, 0
    v_mov_b32 v57, 0
    v_mov_b32 v58, 0
    v_mov_b32 v59, 0
    v_mov_b32 v60, 0
    v_mov_b32 v61, 0
    v_mov_b32 v62, 0
    v_mov_b32 v63, 0
    v_mov_b32 v216, 0
    v_mov_b32 v217, 0
    v_mov_b32 v218, 0
    v_mov_b32 v219, 0
    v_mov_b32 v220, 0
    v_mov_b32 v221, 0
    v_mov_b32 v222, 0
    v_mov_b32 v223, 0
    s_mov_b32 s30, 0
L_slow2:
    v_add_u32 v253, s30, v248
    ds_read_b128 v[228:231], v253 offset:0
    ds_read_b128 v[232:235], v253 offset:1024
    ds_read_b128 v[236:239], v253 offset:2048
    ds_read_b128 v[240:243], v253 offset:3072
    ds_read_b128 v[176:179], v253 offset:4096
    ds_read_b128 v[180:183], v253 offset:5120
    ds_read_b128 v[184:187], v253 offset:6144
    ds_read_b128 v[188:191], v253 offset:7168
    s_waitcnt lgkmcnt(0)
    v_mfma_f32_16x16x32_bf16 v[160:163], v[228:231], v[64:67], v[208:211]
    v_mfma_f32_16x16x32_bf16 v[168:171], v[228:231], v[80:83], v[212:215]
    v_mfma_f32_16x16x32_bf16 v[160:163], v[232:235], v[68:71], v[160:163]
    v_mfma_f32_16x16x32_bf16 v[168:171], v[232:235], v[84:87], v[168:171]
    v_mfma_f32_16x16x32_bf16 v[160:163], v[236:239], v[72:75], v[160:163]
    v_mfma_f32_16x16x32_bf16 v[168:171], v[236:239], v[88:91], v[168:171]
    v_mfma_f32_16x16x32_bf16 v[160:163], v[240:243], v[76:79], v[160:163]
    v_mfma_f32_16x16x32_bf16 v[168:171], v[240:243], v[92:95], v[168:171]
    v_mfma_f32_16x16x32_bf16 v[164:167], v[176:179], v[64:67], v[208:211]
    v_mfma_f32_16x16x32_bf16 v[172:175], v[176:179], v[80:83], v[212:215]
    v_mfma_f32_16x16x32_bf16 v[164:167], v[180:183], v[68:71], v[164:167]
    v_mfma_f32_16x16x32_bf16 v[172:175], v[180:183], v[84:87], v[172:175]
    v_mfma_f32_16x16x32_bf16 v[164:167], v[184:187], v[72:75], v[164:167]
    v_mfma_f32_16x16x32_bf16 v[172:175], v[184:187], v[88:91], v[172:175]
    v_mfma_f32_16x16x32_bf16 v[164:167], v[188:191], v[76:79], v[164:167]
    v_mfma_f32_16x16x32_bf16 v[172:175], v[188:191], v[92:95], v[172:175]
    s_nop 15
    v_add_u32 v253, s30, v250
    ds_read_b128 v[228:231], v253 offset:0
    ds_read_b128 v[232:235], v253 offset:1024
    ds_read_b128 v[236:239], v253 offset:2048
    ds_read_b128 v[240:243], v253 offset:3072
    ds_read_b128 v[176:179], v253 offset:4096
    ds_read_b128 v[180:183], v253 offset:5120
    ds_read_b128 v[184:187], v253 offset:6144
    ds_read_b128 v[188:191], v253 offset:7168
    v_exp_f32 v160, v160
    v_exp_f32 v161, v161
    v_exp_f32 v162, v162
    v_exp_f32 v163, v163
    v_exp_f32 v164, v164
    v_exp_f32 v165, v165
    v_exp_f32 v166, v166
    v_exp_f32 v167, v167
    v_exp_f32 v168, v168
    v_exp_f32 v169, v169
    v_exp_f32 v170, v170
    v_exp_f32 v171, v171
    v_exp_f32 v172, v172
    v_exp_f32 v173, v173
    v_exp_f32 v174, v174
    v_exp_f32 v175, v175
    s_nop 1
    v_cvt_pk_bf16_f32 v192, v160, v161
    v_cvt_pk_bf16_f32 v193, v162, v163
    v_cvt_pk_bf16_f32 v194, v164, v165
    v_cvt_pk_bf16_f32 v195, v166, v167
    v_cvt_pk_bf16_f32 v196, v168, v169
    v_cvt_pk_bf16_f32 v197, v170, v171
    v_cvt_pk_bf16_f32 v198, v172, v173
    v_cvt_pk_bf16_f32 v199, v174, v175
    s_waitcnt lgkmcnt(0)
    s_nop 1
    v_mfma_f32_16x16x32_bf16 v[216:219], v[224:227], v[192:195], v[216:219]
    v_mfma_f32_16x16x32_bf16 v[220:223], v[224:227], v[196:199], v[220:223]
    v_mfma_f32_16x16x32_bf16 v[0:3], v[228:231], v[192:195], v[0:3]
    v_mfma_f32_16x16x32_bf16 v[32:35], v[228:231], v[196:199], v[32:35]
    v_mfma_f32_16x16x32_bf16 v[4:7], v[232:235], v[192:195], v[4:7]
    v_mfma_f32_16x16x32_bf16 v[36:39], v[232:235], v[196:199], v[36:39]
    v_mfma_f32_16x16x32_bf16 v[8:11], v[236:239], v[192:195], v[8:11]
    v_mfma_f32_16x16x32_bf16 v[40:43], v[236:239], v[196:199], v[40:43]
    v_mfma_f32_16x16x32_bf16 v[12:15], v[240:243], v[192:195], v[12:15]
    v_mfma_f32_16x16x32_bf16 v[44:47], v[240:243], v[196:199], v[44:47]
    v_mfma_f32_16x16x32_bf16 v[16:19], v[176:179], v[192:195], v[16:19]
    v_mfma_f32_16x16x32_bf16 v[48:51], v[176:179], v[196:199], v[48:51]
    v_mfma_f32_16x16x32_bf16 v[20:23], v[180:183], v[192:195], v[20:23]
    v_mfma_f32_16x16x32_bf16 v[52:55], v[180:183], v[196:199], v[52:55]
    v_mfma_f32_16x16x32_bf16 v[24:27], v[184:187], v[192:195], v[24:27]
    v_mfma_f32_16x16x32_bf16 v[56:59], v[184:187], v[196:199], v[56:59]
    v_mfma_f32_16x16x32_bf16 v[28:31], v[188:191], v[192:195], v[28:31]
    v_mfma_f32_16x16x32_bf16 v[60:63], v[188:191], v[196:199], v[60:63]
    s_nop 7
    s_add_u32 s30, s30, 8192
    s_cmp_lt_u32 s30, 81920
    s_cbranch_scc1 L_slow2
    s_nop 15
    s_setpc_b64 s[40:41]
.if (. - L_pc) < 32768
.fill ((32768 - (. - L_pc)) / 4), 4, 0xbf810000
.endif
.section .rodata,"a"
.p2align 6
.amdhsa_kernel standalone__gqa_softmax__near_ridge_kernel
  .amdhsa_next_free_vgpr 256
  .amdhsa_next_free_sgpr 64
  .amdhsa_accum_offset 256
  .amdhsa_group_segment_fixed_size 0
  .amdhsa_kernarg_size 48
  .amdhsa_user_sgpr_count 2
  .amdhsa_user_sgpr_kernarg_segment_ptr 1
  .amdhsa_system_sgpr_workgroup_id_x 1
.end_amdhsa_kernel
```
